```python
import torch

def _softmax(x, axis=-1):
    return torch.softmax(x, dim=axis)
def _gelu(x):
    return torch.nn.functional.gelu(x, approximate="tanh")
def _silu(x):
    return torch.nn.functional.silu(x)
def _sigmoid(x):
    return torch.sigmoid(x)
def _layernorm(x, axis=-1, eps=1e-5):
    m = x.mean(dim=axis, keepdim=True)
    v = x.var(dim=axis, keepdim=True, unbiased=False)
    return (x - m) / torch.sqrt(v + eps)
def _scatter_add(tgt, idx, src, axis=0):
    return tgt.clone().index_add_(axis, idx, src)
def _segment_sum(src, seg, n):
    out = torch.zeros((n,) + src.shape[1:], dtype=src.dtype)
    return out.index_add_(0, seg, src)
def _pad(x, pw):
    flat = tuple(v for pair in reversed(pw) for v in pair)
    return torch.nn.functional.pad(x, flat)

kernel_name = 'sequential_preLN__linear_kernel_hedgehog__dense_activation_gelu__prompt'

def setup_inputs():

    _w = (lambda a: (lambda t: t.to(torch.bfloat16) if t.is_floating_point() else t)(torch.as_tensor(a)))
    def _A_setup():
        B, S, D, H = 1, 2048, 512, 32
        Dh = D // H
        return {
            "x": _w((lambda *s: torch.randn(*s, dtype=torch.bfloat16) * 0.05)(B, S, D)),
            "wqkv": _w((lambda *s: torch.randn(*s, dtype=torch.bfloat16) * 0.2)(D, 3 * D)),
            "w_phi": _w((lambda *s: torch.randn(*s, dtype=torch.bfloat16) * 0.2)(H, Dh, Dh) * (Dh ** -0.5)),
            "wo": _w((lambda *s: torch.randn(*s, dtype=torch.bfloat16) * 0.05)(D, D)),
        }
    _A_in = _A_setup()

    def _B_setup():
        B, S, D, F = 1, 2048, 512, 1792
        return {
            "x": _w((lambda *s: torch.randn(*s, dtype=torch.bfloat16) * 0.05)(B, S, D)),
            "w1": _w((lambda *s: torch.randn(*s, dtype=torch.bfloat16) * 3.2)(D, F) * (D ** -0.5)),
            "b1": _w((lambda *s: torch.randn(*s, dtype=torch.bfloat16) * 0.1)(F) * 0.01),
            "w2": _w((lambda *s: torch.randn(*s, dtype=torch.bfloat16) * 0.1)(F, D) * (F ** -0.5)),
            "b2": _w((lambda *s: torch.randn(*s, dtype=torch.bfloat16) * 0.1)(D) * 0.01),
        }
    _B_in = _B_setup()

    return {
        "A_x": _A_in["x"],
        "A_wqkv": _A_in["wqkv"],
        "A_w_phi": _A_in["w_phi"],
        "A_wo": _A_in["wo"],
        "B_x": _B_in["x"],
        "B_w1": _B_in["w1"],
        "B_b1": _B_in["b1"],
        "B_w2": _B_in["w2"],
        "B_b2": _B_in["b2"],
    }

def reference(A_x, A_wqkv, A_w_phi, A_wo, B_x, B_w1, B_b1, B_w2, B_b2):
    def _A_ref(x, wqkv, w_phi, wo):
        B, S, D = x.shape
        H = 32; Dh = D // H
        qkv = (lambda x, *d: x.permute(*d))((x @ wqkv).reshape(B, S, 3, H, Dh), 2, 0, 3, 1, 4)
        q, k, v = qkv[0], qkv[1], qkv[2]
        pq = torch.einsum("bhsd,hdf->bhsf", q, w_phi)
        pk = torch.einsum("bhsd,hdf->bhsf", k, w_phi)
        phi_q = torch.concatenate([_softmax(pq, axis=-1), _softmax(-pq, axis=-1)], axis=-1)
        phi_k = torch.concatenate([_softmax(pk, axis=-1), _softmax(-pk, axis=-1)], axis=-1)
        kv = torch.einsum("bhsf,bhsd->bhfd", phi_k, v)
        z  = torch.einsum("bhsf->bhf", phi_k)
        num = torch.einsum("bhqf,bhfd->bhqd", phi_q, kv)
        den = torch.einsum("bhqf,bhf->bhq", phi_q, z)[..., None] + 1e-6
        o = num / den
        return (lambda x, *d: x.permute(*d))(o, 0, 2, 1, 3).reshape(B, S, D) @ wo

    def _B_ref(x, w1, b1, w2, b2):
        h = torch.einsum("bsd,df->bsf", x, w1) + b1
        h = _gelu(h)
        return torch.einsum("bsf,fd->bsd", h, w2) + b2

    x = A_x
    h = x + _A_ref(_layernorm(x, axis=-1), A_wqkv, A_w_phi, A_wo)
    h2 = h + _B_ref(_layernorm(h, axis=-1), B_w1, B_b1, B_w2, B_b2)
    return h2
```

```asm
; @launch grid=(256,1,1) block=(256,1,1) lds=163840
.amdgcn_target "amdgcn-amd-amdhsa--gfx950"
.text
.globl sequential_preLN__linear_kernel_hedgehog__dense_activation_gelu__prompt_kernel
.p2align 8
.type sequential_preLN__linear_kernel_hedgehog__dense_activation_gelu__prompt_kernel,@function
sequential_preLN__linear_kernel_hedgehog__dense_activation_gelu__prompt_kernel:
  s_cmp_ge_u32 s2, 256
  s_cbranch_scc1 L_end
  s_load_dwordx2 s[8:9], s[0:1], 0
  s_load_dwordx2 s[12:13], s[0:1], 8
  s_load_dwordx2 s[28:29], s[0:1], 88
  v_lshrrev_b32 v250, 6, v0
  s_lshr_b32 s51, s2, 3
  v_and_b32 v0, 63, v0
  v_readfirstlane_b32 s3, v250
  s_and_b32 s5, s51, 7
  s_lshr_b32 s52, s2, 6
  v_and_b32 v249, 15, v0
  v_lshrrev_b32 v248, 4, v0
  s_and_b32 s4, s2, 7
  s_lshl2_add_u32 s4, s4, s52
  s_cmp_eq_u32 s5, 3
  s_cselect_b32 s6, s52, 0
  s_add_u32 s6, s6, s2
  s_add_u32 s6, s6, 0
  s_and_b32 s6, s6, 3
  v_xor_b32 v255, v249, v248
  v_lshlrev_b32 v255, 4, v255
  v_lshl_or_b32 v235, v248, 10, v255
  s_lshl2_add_u32 s70, s4, s3
  s_lshl_b32 s70, s70, 14
  s_lshl_b32 s75, s6, 8
  s_add_u32 s75, s75, s70
  s_lshl_b32 s72, s3, 12
  s_mov_b32 m0, s72
  s_mov_b32 s10, 2097152
  s_mov_b32 s11, 0x20000
  v_xor_b32_e64 v234, 64, v235
  v_add_u32 v234, 3072, v234
  v_xor_b32 v233, 128, v235
  v_add_u32 v233, 6144, v233
  v_xor_b32 v232, 192, v235
  v_add_u32 v232, 9216, v232
  v_lshrrev_b32 v247, 3, v0
  v_and_b32_e64 v255, 6, v247
  s_waitcnt lgkmcnt(0)
  buffer_load_dwordx4 v235, s[8:11], s75 offen offset:0 nt lds
  v_and_b32 v254, 7, v0
  v_xor_b32 v229, v255, v254
  v_lshlrev_b32_e64 v229, 4, v229
  buffer_load_dwordx4 v234, s[8:11], s75 offen offset:1024 nt lds
  v_and_b32 v255, 4, v247
  v_add_u32 v255, v255, v247
  v_mul_u32_u24 v255, 3072, v255
  buffer_load_dwordx4 v233, s[8:11], s75 offen offset:2048 nt lds
  v_add_u32_e64 v231, v255, v229
  v_add_u32 v230, 1024, v231
  s_mov_b32 s14, 1572864
  buffer_load_dwordx4 v232, s[8:11], s75 offen offset:3072 nt lds
  s_mov_b32 s15, 0x20000
  s_and_b32 s53, s3, 1
  s_lshr_b32 s52, s3, 1
  s_lshl2_add_u32 s53, s53, s52
  s_mul_i32 s53, s53, 96
  s_add_u32 s53, s53, s5
  s_add_u32 s53, s53, 8
  s_lshl_b32 s53, s53, 7
  s_mul_i32 s79, s6, 393216
  s_add_u32 s79, s79, s53
  s_lshl_b32 s74, s3, 10
  s_lshr_b32 s73, s2, 1
  s_and_b32 s73, s73, 2
  s_mul_i32 s83, s73, 98304
  s_add_u32 m0, s74, 65536
  s_add_u32 s61, s79, s83
  buffer_load_dwordx4 v231, s[12:15], s61 offen lds
  s_add_u32 m0, s74, 131072
  s_nop 0
  buffer_load_dwordx4 v230, s[12:15], s61 offen lds
  s_load_dword s7, s[28:29], 0
  s_xor_b32 s84, s73, 1
  s_mul_i32 s84, s84, 98304
  s_add_u32 m0, s74, 69632
  s_add_u32 s61, s79, s84
  buffer_load_dwordx4 v231, s[12:15], s61 offen lds
  s_add_u32 m0, s74, 135168
  s_nop 0
  buffer_load_dwordx4 v230, s[12:15], s61 offen lds
  s_xor_b32 s85, s73, 2
  s_mul_i32 s85, s85, 98304
  s_add_u32 m0, s74, 73728
  s_add_u32 s61, s79, s85
  buffer_load_dwordx4 v231, s[12:15], s61 offen lds
  s_add_u32 m0, s74, 139264
  s_nop 0
  buffer_load_dwordx4 v230, s[12:15], s61 offen lds
  s_xor_b32 s86, s73, 3
  s_mul_i32 s86, s86, 98304
  s_add_u32 s52, s6, 1
  s_and_b32 s52, s52, 3
  s_mul_i32 s80, s52, 393216
  s_add_u32 s80, s80, s53
  s_lshl_b32 s76, s52, 8
  s_add_u32 s76, s76, s70
  s_add_u32 s52, s6, 2
  s_and_b32 s52, s52, 3
  s_mul_i32 s81, s52, 393216
  s_add_u32 s81, s81, s53
  s_lshl_b32 s77, s52, 8
  s_add_u32 s77, s77, s70
  s_add_u32 s52, s6, 3
  s_and_b32 s52, s52, 3
  s_mul_i32 s82, s52, 393216
  s_add_u32 s82, s82, s53
  s_lshl_b32 s78, s52, 8
  s_add_u32 s78, s78, s70
  s_load_dwordx2 s[16:17], s[0:1], 24
  s_load_dwordx2 s[36:37], s[0:1], 16
  s_load_dwordx2 s[20:21], s[0:1], 40
  s_load_dwordx2 s[24:25], s[0:1], 56
  s_load_dwordx2 s[32:33], s[0:1], 72
  s_load_dwordx2 s[40:41], s[0:1], 48
  s_load_dwordx2 s[44:45], s[0:1], 64
  s_lshl2_add_u32 s51, s51, s3
  s_lshl_b32 s51, s51, 9
  v_lshl_add_u32 v254, v0, 7, s51
  s_getpc_b64 s[68:69]
L_ct0:
  v_min_u32 v254, L_last-L_ct0-64, v254
  v_mov_b32 v227, s69
  v_add_co_u32 v226, vcc, s68, v254
  s_nop 1
  v_addc_co_u32 v227, vcc, 0, v227, vcc
  s_mov_b64 exec, 15
  global_load_dword v250, v[226:227], off
  s_mov_b64 exec, -1
  v_xor_b32 v255, v249, v248
  v_lshlrev_b32_e64 v255, 4, v255
  v_lshl_or_b32 v255, v249, 8, v255
  s_lshl_b32 s51, s73, 6
  s_or_b32 s51, s51, s72
  v_xor_b32_e64 v227, s51, v255
  v_xor_b32 v223, 4096, v227
  v_xor_b32 v219, 8192, v227
  v_xor_b32 v215, 12288, v227
  v_xor_b32_e64 v226, 64, v227
  v_xor_b32 v222, 4160, v227
  v_xor_b32 v218, 8256, v227
  v_xor_b32 v214, 12352, v227
  v_xor_b32 v225, 128, v227
  v_xor_b32 v221, 4224, v227
  v_xor_b32 v217, 8320, v227
  v_xor_b32 v213, 12416, v227
  v_xor_b32 v224, 192, v227
  v_xor_b32 v220, 4288, v227
  v_xor_b32 v216, 8384, v227
  v_xor_b32 v212, 12480, v227
  v_lshrrev_b32 v255, 2, v0
  v_lshlrev_b32 v254, 7, v255
  v_and_b32_e64 v253, 3, v0
  v_lshl_or_b32 v254, v253, 3, v254
  v_and_b32_e64 v255, 6, v255
  v_lshl_or_b32 v211, v255, 4, v254
  s_lshl_b32 s51, s3, 5
  v_xor_b32 v210, s51, v211
  v_add_u32 v209, 65536, v210
  v_add_u32 v208, 131072, v210
  v_mov_b32 v4, 0x3f803f80
  v_mov_b32 v5, 0x3f803f80
  v_mov_b32 v6, 0x3f803f80
  v_mov_b32 v7, 0x3f803f80
  s_waitcnt lgkmcnt(0)
  s_mov_b32 s18, 524288
  s_mov_b32 s19, 0x20000
  s_mov_b32 s22, 1835008
  s_mov_b32 s23, 0x20000
  s_mov_b32 s26, 1835008
  s_mov_b32 s27, 0x20000
  s_mov_b32 s30, 41943040
  s_mov_b32 s31, 0x20000
  s_mov_b32 s34, 2097152
  s_mov_b32 s35, 0x20000
  s_mov_b32 s38, 16384
  s_mov_b32 s39, 0x20000
  s_mov_b32 s42, 3584
  s_mov_b32 s43, 0x20000
  s_mov_b32 s46, 1024
  s_mov_b32 s47, 0x20000
  s_lshr_b32 s50, s4, 1
  s_and_b32 s49, s4, 1
  s_lshl3_add_u32 s49, s49, s5
  s_getreg_b32 s48, hwreg(HW_REG_XCC_ID, 0, 4)
  s_mul_i32 s7, s7, 0x9E3779B1
  s_add_u32 s7, s7, 0x7F4A7C15
  v_lshlrev_b32 v228, 7, v0
  v_mov_b32 v202, s48
  v_mov_b32 v245, s7
  v_mov_b32 v203, s7
  v_lshlrev_b32 v201, 1, v249
  v_lshl_or_b32 v201, v248, 7, v201
  s_lshl_b32 s71, s3, 11
  v_lshlrev_b32 v246, 4, v0
  s_add_u32 m0, s74, 77824
  s_add_u32 s61, s79, s86
  buffer_load_dwordx4 v231, s[12:15], s61 offen lds
  s_add_u32 m0, s74, 143360
  s_nop 0
  buffer_load_dwordx4 v230, s[12:15], s61 offen lds
  s_add_u32 m0, s72, 16384
  s_nop 0
  buffer_load_dwordx4 v235, s[8:11], s76 offen offset:0 nt lds
  buffer_load_dwordx4 v234, s[8:11], s76 offen offset:1024 nt lds
  buffer_load_dwordx4 v233, s[8:11], s76 offen offset:2048 nt lds
  buffer_load_dwordx4 v232, s[8:11], s76 offen offset:3072 nt lds
  s_add_u32 m0, s74, 81920
  s_add_u32 s61, s80, s83
  buffer_load_dwordx4 v231, s[12:15], s61 offen lds
  s_add_u32 m0, s74, 147456
  s_nop 0
  buffer_load_dwordx4 v230, s[12:15], s61 offen lds
  s_waitcnt vmcnt(13)
  s_barrier
  ds_read_b64_tr_b16 v[60:61], v209 offset:0
  ds_read_b64_tr_b16 v[62:63], v209 offset:2048
  ds_read_b128 a[0:3], v227 offset:0
  ds_read_b128 a[4:7], v223 offset:0
  ds_read_b128 a[8:11], v219 offset:0
  ds_read_b128 a[12:15], v215 offset:0
  ds_read_b64_tr_b16 v[68:69], v208 offset:0
  ds_read_b64_tr_b16 v[70:71], v208 offset:2048
  s_waitcnt lgkmcnt(0)
  s_waitcnt vmcnt(11)
  s_barrier
  v_mfma_f32_16x16x32_bf16 v[12:15], v[60:63], a[0:3], 0
  ds_read_b64_tr_b16 v[64:65], v209 offset:4096
  s_add_u32 m0, s74, 86016
  v_mfma_f32_16x16x32_bf16 v[16:19], v[60:63], a[4:7], 0
  ds_read_b64_tr_b16 v[66:67], v209 offset:6144
  s_add_u32 s61, s80, s84
  v_mfma_f32_16x16x32_bf16 v[20:23], v[60:63], a[8:11], 0
  ds_read_b128 a[16:19], v226 offset:0
  buffer_load_dwordx4 v231, s[12:15], s61 offen lds
  v_mfma_f32_16x16x32_bf16 v[24:27], v[60:63], a[12:15], 0
  ds_read_b128 a[20:23], v222 offset:0
  s_add_u32 m0, s74, 151552
  v_mfma_f32_16x16x32_bf16 v[44:47], a[0:3], a[0:3], 0
  ds_read_b128 a[24:27], v218 offset:0
  buffer_load_dwordx4 v230, s[12:15], s61 offen lds
  v_mfma_f32_16x16x32_bf16 v[48:51], v[4:7], a[0:3], 0
  ds_read_b128 a[28:31], v214 offset:0
  s_add_u32 m0, s74, 90112
  v_mfma_f32_16x16x32_bf16 v[52:55], v[60:63], v[4:7], 0
  ds_read_b64_tr_b16 v[72:73], v208 offset:4096
  v_mfma_f32_16x16x32_bf16 v[28:31], v[68:71], a[0:3], 0
  s_add_u32 s61, s80, s85
  v_mfma_f32_16x16x32_bf16 v[32:35], v[68:71], a[4:7], 0
  ds_read_b64_tr_b16 v[74:75], v208 offset:6144
  v_mfma_f32_16x16x32_bf16 v[36:39], v[68:71], a[8:11], 0
  buffer_load_dwordx4 v231, s[12:15], s61 offen lds
  v_mfma_f32_16x16x32_bf16 v[40:43], v[68:71], a[12:15], 0
  v_lshlrev_b32 v244, 7, v249
  v_and_b32 v255, 3, v0
  v_cmp_eq_u32 s[62:63], 1, v255
  v_cmp_eq_u32 s[64:65], 2, v255
  v_cmp_eq_u32 s[66:67], 3, v255
  v_mov_b32 v254, 0x3f80
  v_mov_b32 v253, 0x3f800000
  v_mov_b32 v252, 0
  v_mfma_f32_16x16x32_bf16 v[56:59], v[68:71], v[4:7], 0
  v_cndmask_b32 v204, v254, v253, s[62:63]
  v_cndmask_b32 v205, v253, v254, s[64:65]
  v_cmp_gt_u32 vcc, 2, v255
  v_lshrrev_b32 v251, 2, v249
  v_cmp_eq_u32 s[88:89], v251, v248
  v_cndmask_b32 v204, v252, v204, vcc
  v_cndmask_b32 v205, v205, v252, vcc
  v_cndmask_b32 v206, v252, v204, s[88:89]
  s_waitcnt vmcnt(12)
  s_barrier
  s_waitcnt lgkmcnt(0)
  v_mfma_f32_16x16x32_bf16 v[12:15], v[64:67], a[16:19], v[12:15]
  ds_read_b64_tr_b16 v[60:61], v209 offset:8192
  s_add_u32 m0, s74, 155648
  v_mfma_f32_16x16x32_bf16 v[16:19], v[64:67], a[20:23], v[16:19]
  ds_read_b64_tr_b16 v[62:63], v209 offset:10240
  buffer_load_dwordx4 v230, s[12:15], s61 offen lds
  v_mfma_f32_16x16x32_bf16 v[20:23], v[64:67], a[24:27], v[20:23]
  ds_read_b128 a[32:35], v225 offset:0
  s_add_u32 m0, s74, 94208
  v_mfma_f32_16x16x32_bf16 v[24:27], v[64:67], a[28:31], v[24:27]
  ds_read_b128 a[36:39], v221 offset:0
  s_add_u32 s61, s80, s86
  v_mfma_f32_16x16x32_bf16 v[44:47], a[16:19], a[16:19], v[44:47]
  ds_read_b128 a[40:43], v217 offset:0
  buffer_load_dwordx4 v231, s[12:15], s61 offen lds
  v_mfma_f32_16x16x32_bf16 v[48:51], v[4:7], a[16:19], v[48:51]
  ds_read_b128 a[44:47], v213 offset:0
  v_mfma_f32_16x16x32_bf16 v[52:55], v[64:67], v[4:7], v[52:55]
  s_add_u32 m0, s74, 159744
  v_mfma_f32_16x16x32_bf16 v[28:31], v[72:75], a[16:19], v[28:31]
  ds_read_b64_tr_b16 v[68:69], v208 offset:8192
  v_mfma_f32_16x16x32_bf16 v[32:35], v[72:75], a[20:23], v[32:35]
  buffer_load_dwordx4 v230, s[12:15], s61 offen lds
  v_mfma_f32_16x16x32_bf16 v[36:39], v[72:75], a[24:27], v[36:39]
  ds_read_b64_tr_b16 v[70:71], v208 offset:10240
  v_mfma_f32_16x16x32_bf16 v[40:43], v[72:75], a[28:31], v[40:43]
  v_cndmask_b32 v207, v252, v205, s[88:89]
  s_lshl_b32 s51, s3, 7
  s_add_u32 s51, s51, 81920
  v_lshl_add_u32 v193, v249, 3, s51
  v_lshlrev_b32 v194, 4, v249
  v_lshl_or_b32 v194, v248, 13, v194
  s_lshl2_add_u32 s51, s5, s3
  s_lshl_b32 s87, s51, 11
  v_mfma_f32_16x16x32_bf16 v[56:59], v[72:75], v[4:7], v[56:59]
  s_add_u32 s87, s87, 65536
  s_lshl_b32 s91, s51, 8
  s_add_u32 s91, s91, s4
  s_lshl_b32 s91, s91, 8
  s_add_u32 s91, s91, 2097152
  s_lshl_b32 s6, s5, 5
  s_add_u32 s6, s6, s4
  s_lshl_b32 s6, s6, 13
  s_waitcnt vmcnt(12)
  s_barrier
  s_waitcnt lgkmcnt(0)
  v_mfma_f32_16x16x32_bf16 v[12:15], v[60:63], a[32:35], v[12:15]
  ds_read_b64_tr_b16 v[64:65], v209 offset:12288
  s_add_u32 m0, s72, 32768
  v_mfma_f32_16x16x32_bf16 v[16:19], v[60:63], a[36:39], v[16:19]
  ds_read_b64_tr_b16 v[66:67], v209 offset:14336
  buffer_load_dwordx4 v235, s[8:11], s77 offen offset:0 nt lds
  v_mfma_f32_16x16x32_bf16 v[20:23], v[60:63], a[40:43], v[20:23]
  ds_read_b128 a[48:51], v224 offset:0
  v_mfma_f32_16x16x32_bf16 v[24:27], v[60:63], a[44:47], v[24:27]
  buffer_load_dwordx4 v234, s[8:11], s77 offen offset:1024 nt lds
  v_mfma_f32_16x16x32_bf16 v[44:47], a[32:35], a[32:35], v[44:47]
  ds_read_b128 a[52:55], v220 offset:0
  v_mfma_f32_16x16x32_bf16 v[48:51], v[4:7], a[32:35], v[48:51]
  buffer_load_dwordx4 v233, s[8:11], s77 offen offset:2048 nt lds
  v_mfma_f32_16x16x32_bf16 v[52:55], v[60:63], v[4:7], v[52:55]
  ds_read_b128 a[56:59], v216 offset:0
  v_mfma_f32_16x16x32_bf16 v[28:31], v[68:71], a[32:35], v[28:31]
  ds_read_b128 a[60:63], v212 offset:0
  v_mfma_f32_16x16x32_bf16 v[32:35], v[68:71], a[36:39], v[32:35]
  ds_read_b64_tr_b16 v[72:73], v208 offset:12288
  v_mfma_f32_16x16x32_bf16 v[36:39], v[68:71], a[40:43], v[36:39]
  ds_read_b64_tr_b16 v[74:75], v208 offset:14336
  v_mfma_f32_16x16x32_bf16 v[40:43], v[68:71], a[44:47], v[40:43]
  s_add_u32 s6, s6, 2097152
  s_lshl_b32 s90, s50, 11
  s_add_u32 s90, s90, 32768
  s_mov_b32 s68, 1069066811
  s_mov_b32 s69, 3216550459
  s_add_u32 s51, s3, 4
  s_min_u32 s51, s51, 6
  v_mov_b32_e64 v186, s3
  v_mfma_f32_16x16x32_bf16 v[56:59], v[68:71], v[4:7], v[56:59]
  v_mov_b32 v254, s51
  v_cmp_gt_u32 vcc, 8, v249
  s_nop 1
  v_cndmask_b32 v186, v254, v186, vcc
  v_lshlrev_b32_e64 v186, 5, v186
  v_lshl_or_b32 v186, v248, 3, v186
  v_and_b32 v255, 3, v0
  v_lshlrev_b32 v255, 5, v255
  v_lshl_or_b32 v185, v248, 3, v255
  s_waitcnt vmcnt(9)
  s_barrier
  s_waitcnt lgkmcnt(0)
  v_mfma_f32_16x16x32_bf16 v[12:15], v[64:67], a[48:51], v[12:15]
  ds_read_b64_tr_b16 v[60:61], v209 offset:16384
  buffer_load_dwordx4 v232, s[8:11], s77 offen offset:3072 nt lds
  v_mfma_f32_16x16x32_bf16 v[16:19], v[64:67], a[52:55], v[16:19]
  ds_read_b64_tr_b16 v[62:63], v209 offset:18432
  s_add_u32 m0, s74, 98304
  v_mfma_f32_16x16x32_bf16 v[20:23], v[64:67], a[56:59], v[20:23]
  ds_read_b128 a[64:67], v227 offset:16384
  s_add_u32 s61, s81, s83
  v_mfma_f32_16x16x32_bf16 v[24:27], v[64:67], a[60:63], v[24:27]
  ds_read_b128 a[68:71], v223 offset:16384
  buffer_load_dwordx4 v231, s[12:15], s61 offen lds
  v_mfma_f32_16x16x32_bf16 v[44:47], a[48:51], a[48:51], v[44:47]
  ds_read_b128 a[72:75], v219 offset:16384
  v_mfma_f32_16x16x32_bf16 v[48:51], v[4:7], a[48:51], v[48:51]
  s_add_u32 m0, s74, 65536
  v_mfma_f32_16x16x32_bf16 v[52:55], v[64:67], v[4:7], v[52:55]
  ds_read_b128 a[76:79], v215 offset:16384
  v_mfma_f32_16x16x32_bf16 v[28:31], v[72:75], a[48:51], v[28:31]
  buffer_load_dwordx4 v230, s[12:15], s61 offen lds
  v_mfma_f32_16x16x32_bf16 v[32:35], v[72:75], a[52:55], v[32:35]
  ds_read_b64_tr_b16 v[68:69], v208 offset:16384
  v_mfma_f32_16x16x32_bf16 v[36:39], v[72:75], a[56:59], v[36:39]
  ds_read_b64_tr_b16 v[70:71], v208 offset:18432
  v_mfma_f32_16x16x32_bf16 v[40:43], v[72:75], a[60:63], v[40:43]
  v_lshlrev_b32_e64 v192, 2, v186
  v_mfma_f32_16x16x32_bf16 v[56:59], v[72:75], v[4:7], v[56:59]
  v_add_u32 v192, 125952, v192
  s_waitcnt vmcnt(10)
  s_barrier
  s_waitcnt lgkmcnt(0)
  v_mfma_f32_16x16x32_bf16 v[12:15], v[60:63], a[64:67], v[12:15]
  ds_read_b64_tr_b16 v[64:65], v209 offset:20480
  s_add_u32 m0, s74, 102400
  v_mfma_f32_16x16x32_bf16 v[16:19], v[60:63], a[68:71], v[16:19]
  ds_read_b64_tr_b16 v[66:67], v209 offset:22528
  s_add_u32 s61, s81, s84
  v_mfma_f32_16x16x32_bf16 v[20:23], v[60:63], a[72:75], v[20:23]
  ds_read_b128 a[80:83], v226 offset:16384
  buffer_load_dwordx4 v231, s[12:15], s61 offen lds
  v_mfma_f32_16x16x32_bf16 v[24:27], v[60:63], a[76:79], v[24:27]
  ds_read_b128 a[84:87], v222 offset:16384
  s_add_u32 m0, s74, 69632
  v_mfma_f32_16x16x32_bf16 v[44:47], a[64:67], a[64:67], v[44:47]
  ds_read_b128 a[88:91], v218 offset:16384
  buffer_load_dwordx4 v230, s[12:15], s61 offen lds
  v_mfma_f32_16x16x32_bf16 v[48:51], v[4:7], a[64:67], v[48:51]
  ds_read_b128 a[92:95], v214 offset:16384
  s_add_u32 m0, s74, 106496
  v_mfma_f32_16x16x32_bf16 v[52:55], v[60:63], v[4:7], v[52:55]
  ds_read_b64_tr_b16 v[72:73], v208 offset:20480
  v_mfma_f32_16x16x32_bf16 v[28:31], v[68:71], a[64:67], v[28:31]
  s_add_u32 s61, s81, s85
  v_mfma_f32_16x16x32_bf16 v[32:35], v[68:71], a[68:71], v[32:35]
  ds_read_b64_tr_b16 v[74:75], v208 offset:22528
  v_mfma_f32_16x16x32_bf16 v[36:39], v[68:71], a[72:75], v[36:39]
  buffer_load_dwordx4 v231, s[12:15], s61 offen lds
  v_mfma_f32_16x16x32_bf16 v[40:43], v[68:71], a[76:79], v[40:43]
  v_lshl_add_u32 v243, v247, 10, v229
  v_add_u32 v242, 7168, v243
  v_add_u32 v241, 14336, v243
  v_add_u32 v240, 21504, v243
  v_and_b32 v200, 7, v0
  v_xor_b32 v200, v200, v247
  v_lshlrev_b32 v200, 4, v200
  v_lshl_or_b32 v200, v247, 10, v200
  v_mfma_f32_16x16x32_bf16 v[56:59], v[68:71], v[4:7], v[56:59]
  v_and_b32 v255, 7, v249
  v_lshrrev_b32 v254, 1, v248
  v_xor_b32 v255, v255, v254
  v_lshlrev_b32 v255, 4, v255
  v_lshl_or_b32 v255, v249, 7, v255
  v_and_b32_e64 v254, 1, v248
  v_lshl_or_b32 v255, v254, 3, v255
  s_add_u32 s51, s71, 86016
  s_waitcnt vmcnt(11)
  s_barrier
  s_waitcnt lgkmcnt(0)
  v_mfma_f32_16x16x32_bf16 v[12:15], v[64:67], a[80:83], v[12:15]
  ds_read_b64_tr_b16 v[60:61], v209 offset:24576
  s_add_u32 m0, s74, 73728
  v_mfma_f32_16x16x32_bf16 v[16:19], v[64:67], a[84:87], v[16:19]
  ds_read_b64_tr_b16 v[62:63], v209 offset:26624
  buffer_load_dwordx4 v230, s[12:15], s61 offen lds
  v_mfma_f32_16x16x32_bf16 v[20:23], v[64:67], a[88:91], v[20:23]
  ds_read_b128 a[96:99], v225 offset:16384
  s_add_u32 m0, s74, 110592
  v_mfma_f32_16x16x32_bf16 v[24:27], v[64:67], a[92:95], v[24:27]
  ds_read_b128 a[100:103], v221 offset:16384
  s_add_u32 s61, s81, s86
  v_mfma_f32_16x16x32_bf16 v[44:47], a[80:83], a[80:83], v[44:47]
  ds_read_b128 a[104:107], v217 offset:16384
  buffer_load_dwordx4 v231, s[12:15], s61 offen lds
  v_mfma_f32_16x16x32_bf16 v[48:51], v[4:7], a[80:83], v[48:51]
  ds_read_b128 a[108:111], v213 offset:16384
  v_mfma_f32_16x16x32_bf16 v[52:55], v[64:67], v[4:7], v[52:55]
  s_add_u32 m0, s74, 77824
  v_mfma_f32_16x16x32_bf16 v[28:31], v[72:75], a[80:83], v[28:31]
  ds_read_b64_tr_b16 v[68:69], v208 offset:24576
  v_mfma_f32_16x16x32_bf16 v[32:35], v[72:75], a[84:87], v[32:35]
  buffer_load_dwordx4 v230, s[12:15], s61 offen lds
  v_mfma_f32_16x16x32_bf16 v[36:39], v[72:75], a[88:91], v[36:39]
  ds_read_b64_tr_b16 v[70:71], v208 offset:26624
  v_mfma_f32_16x16x32_bf16 v[40:43], v[72:75], a[92:95], v[40:43]
  v_add_u32 v198, s51, v255
  v_xor_b32 v197, 32, v198
  v_xor_b32_e64 v196, 64, v198
  v_xor_b32 v195, 96, v198
  s_mov_b32 s51, 4682
  v_mul_u32_u24 v254, s51, v0
  v_lshrrev_b32 v254, 16, v254
  v_mul_u32_u24 v254, 3360, v254
  v_mfma_f32_16x16x32_bf16 v[56:59], v[72:75], v[4:7], v[56:59]
  v_lshl_add_u32 v199, v0, 4, v254
  v_xor_b32_e64 v239, 0, v211
  v_add_u32 v239, 98304, v239
  v_xor_b32_e64 v238, 32, v211
  v_add_u32 v238, 98304, v238
  v_xor_b32_e64 v237, 64, v211
  v_add_u32 v237, 98304, v237
  v_xor_b32 v236, 96, v211
  s_waitcnt vmcnt(12)
  s_barrier
  s_waitcnt lgkmcnt(0)
  v_mfma_f32_16x16x32_bf16 v[12:15], v[60:63], a[96:99], v[12:15]
  ds_read_b64_tr_b16 v[64:65], v209 offset:28672
  s_add_u32 m0, s72, 49152
  v_mfma_f32_16x16x32_bf16 v[16:19], v[60:63], a[100:103], v[16:19]
  ds_read_b64_tr_b16 v[66:67], v209 offset:30720
  buffer_load_dwordx4 v235, s[8:11], s78 offen offset:0 nt lds
  v_mfma_f32_16x16x32_bf16 v[20:23], v[60:63], a[104:107], v[20:23]
  ds_read_b128 a[112:115], v224 offset:16384
  v_mfma_f32_16x16x32_bf16 v[24:27], v[60:63], a[108:111], v[24:27]
  buffer_load_dwordx4 v234, s[8:11], s78 offen offset:1024 nt lds
  v_mfma_f32_16x16x32_bf16 v[44:47], a[96:99], a[96:99], v[44:47]
  ds_read_b128 a[116:119], v220 offset:16384
  v_mfma_f32_16x16x32_bf16 v[48:51], v[4:7], a[96:99], v[48:51]
  buffer_load_dwordx4 v233, s[8:11], s78 offen offset:2048 nt lds
  v_mfma_f32_16x16x32_bf16 v[52:55], v[60:63], v[4:7], v[52:55]
  ds_read_b128 a[120:123], v216 offset:16384
  v_mfma_f32_16x16x32_bf16 v[28:31], v[68:71], a[96:99], v[28:31]
  ds_read_b128 a[124:127], v212 offset:16384
  v_mfma_f32_16x16x32_bf16 v[32:35], v[68:71], a[100:103], v[32:35]
  ds_read_b64_tr_b16 v[72:73], v208 offset:28672
  v_mfma_f32_16x16x32_bf16 v[36:39], v[68:71], a[104:107], v[36:39]
  ds_read_b64_tr_b16 v[74:75], v208 offset:30720
  v_mfma_f32_16x16x32_bf16 v[40:43], v[68:71], a[108:111], v[40:43]
  v_add_u32 v236, 98304, v236
  s_add_u32 s92, s2, 0
  v_mfma_f32_16x16x32_bf16 v[56:59], v[68:71], v[4:7], v[56:59]
  s_and_b32 s92, s92, 3
  s_waitcnt vmcnt(9)
  s_barrier
  s_waitcnt lgkmcnt(0)
  v_mfma_f32_16x16x32_bf16 v[12:15], v[64:67], a[112:115], v[12:15]
  ds_read_b64_tr_b16 v[60:61], v209 offset:32768
  buffer_load_dwordx4 v232, s[8:11], s78 offen offset:3072 nt lds
  v_mfma_f32_16x16x32_bf16 v[16:19], v[64:67], a[116:119], v[16:19]
  ds_read_b64_tr_b16 v[62:63], v209 offset:34816
  s_add_u32 m0, s74, 114688
  v_mfma_f32_16x16x32_bf16 v[20:23], v[64:67], a[120:123], v[20:23]
  ds_read_b128 a[128:131], v227 offset:32768
  s_add_u32 s61, s82, s83
  v_mfma_f32_16x16x32_bf16 v[24:27], v[64:67], a[124:127], v[24:27]
  ds_read_b128 a[132:135], v223 offset:32768
  buffer_load_dwordx4 v231, s[12:15], s61 offen lds
  v_mfma_f32_16x16x32_bf16 v[44:47], a[112:115], a[112:115], v[44:47]
  ds_read_b128 a[136:139], v219 offset:32768
  v_mfma_f32_16x16x32_bf16 v[48:51], v[4:7], a[112:115], v[48:51]
  s_add_u32 m0, s74, 81920
  v_mfma_f32_16x16x32_bf16 v[52:55], v[64:67], v[4:7], v[52:55]
  ds_read_b128 a[140:143], v215 offset:32768
  v_mfma_f32_16x16x32_bf16 v[28:31], v[72:75], a[112:115], v[28:31]
  buffer_load_dwordx4 v230, s[12:15], s61 offen lds
  v_mfma_f32_16x16x32_bf16 v[32:35], v[72:75], a[116:119], v[32:35]
  ds_read_b64_tr_b16 v[68:69], v209 offset:0
  v_mfma_f32_16x16x32_bf16 v[36:39], v[72:75], a[120:123], v[36:39]
  ds_read_b64_tr_b16 v[70:71], v209 offset:2048
  v_mfma_f32_16x16x32_bf16 v[40:43], v[72:75], a[124:127], v[40:43]
  v_mfma_f32_16x16x32_bf16 v[56:59], v[72:75], v[4:7], v[56:59]
  s_waitcnt vmcnt(10)
  s_barrier
  s_waitcnt lgkmcnt(0)
  v_mfma_f32_16x16x32_bf16 v[12:15], v[60:63], a[128:131], v[12:15]
  ds_read_b64_tr_b16 v[64:65], v209 offset:36864
  s_add_u32 m0, s74, 118784
  v_mfma_f32_16x16x32_bf16 v[16:19], v[60:63], a[132:135], v[16:19]
  ds_read_b64_tr_b16 v[66:67], v209 offset:38912
  s_add_u32 s61, s82, s84
  v_mfma_f32_16x16x32_bf16 v[20:23], v[60:63], a[136:139], v[20:23]
  ds_read_b128 a[144:147], v226 offset:32768
  buffer_load_dwordx4 v231, s[12:15], s61 offen lds
  v_mfma_f32_16x16x32_bf16 v[24:27], v[60:63], a[140:143], v[24:27]
  ds_read_b128 a[148:151], v222 offset:32768
  s_add_u32 m0, s74, 86016
  v_mfma_f32_16x16x32_bf16 v[44:47], a[128:131], a[128:131], v[44:47]
  ds_read_b128 a[152:155], v218 offset:32768
  buffer_load_dwordx4 v230, s[12:15], s61 offen lds
  v_mfma_f32_16x16x32_bf16 v[48:51], v[4:7], a[128:131], v[48:51]
  ds_read_b128 a[156:159], v214 offset:32768
  s_add_u32 m0, s74, 122880
  v_mfma_f32_16x16x32_bf16 v[52:55], v[60:63], v[4:7], v[52:55]
  ds_read_b64_tr_b16 v[72:73], v209 offset:4096
  v_mfma_f32_16x16x32_bf16 v[28:31], v[68:71], a[128:131], v[28:31]
  s_add_u32 s61, s82, s85
  v_mfma_f32_16x16x32_bf16 v[32:35], v[68:71], a[132:135], v[32:35]
  ds_read_b64_tr_b16 v[74:75], v209 offset:6144
  v_mfma_f32_16x16x32_bf16 v[36:39], v[68:71], a[136:139], v[36:39]
  buffer_load_dwordx4 v231, s[12:15], s61 offen lds
  v_mfma_f32_16x16x32_bf16 v[40:43], v[68:71], a[140:143], v[40:43]
  v_mfma_f32_16x16x32_bf16 v[56:59], v[68:71], v[4:7], v[56:59]
  s_waitcnt vmcnt(11)
  s_barrier
  s_waitcnt lgkmcnt(0)
  v_mfma_f32_16x16x32_bf16 v[12:15], v[64:67], a[144:147], v[12:15]
  ds_read_b64_tr_b16 v[60:61], v209 offset:40960
  s_add_u32 m0, s74, 90112
  v_mfma_f32_16x16x32_bf16 v[16:19], v[64:67], a[148:151], v[16:19]
  ds_read_b64_tr_b16 v[62:63], v209 offset:43008
  buffer_load_dwordx4 v230, s[12:15], s61 offen lds
  v_mfma_f32_16x16x32_bf16 v[20:23], v[64:67], a[152:155], v[20:23]
  ds_read_b128 a[160:163], v225 offset:32768
  s_add_u32 m0, s74, 126976
  v_mfma_f32_16x16x32_bf16 v[24:27], v[64:67], a[156:159], v[24:27]
  ds_read_b128 a[164:167], v221 offset:32768
  s_add_u32 s61, s82, s86
  v_mfma_f32_16x16x32_bf16 v[44:47], a[144:147], a[144:147], v[44:47]
  ds_read_b128 a[168:171], v217 offset:32768
  buffer_load_dwordx4 v231, s[12:15], s61 offen lds
  v_mfma_f32_16x16x32_bf16 v[48:51], v[4:7], a[144:147], v[48:51]
  ds_read_b128 a[172:175], v213 offset:32768
  v_mfma_f32_16x16x32_bf16 v[52:55], v[64:67], v[4:7], v[52:55]
  s_add_u32 m0, s74, 94208
  v_mfma_f32_16x16x32_bf16 v[28:31], v[72:75], a[144:147], v[28:31]
  ds_read_b64_tr_b16 v[68:69], v209 offset:8192
  v_mfma_f32_16x16x32_bf16 v[32:35], v[72:75], a[148:151], v[32:35]
  buffer_load_dwordx4 v230, s[12:15], s61 offen lds
  v_mfma_f32_16x16x32_bf16 v[36:39], v[72:75], a[152:155], v[36:39]
  ds_read_b64_tr_b16 v[70:71], v209 offset:10240
  v_mfma_f32_16x16x32_bf16 v[40:43], v[72:75], a[156:159], v[40:43]
  v_mfma_f32_16x16x32_bf16 v[56:59], v[72:75], v[4:7], v[56:59]
  s_waitcnt vmcnt(12)
  s_barrier
  s_waitcnt lgkmcnt(0)
  v_mfma_f32_16x16x32_bf16 v[12:15], v[60:63], a[160:163], v[12:15]
  ds_read_b64_tr_b16 v[64:65], v209 offset:45056
  s_lshl2_add_u32 s58, s5, s3
  v_mfma_f32_16x16x32_bf16 v[16:19], v[60:63], a[164:167], v[16:19]
  ds_read_b64_tr_b16 v[66:67], v209 offset:47104
  s_lshl_b32 s58, s58, 9
  v_mfma_f32_16x16x32_bf16 v[20:23], v[60:63], a[168:171], v[20:23]
  ds_read_b128 a[176:179], v224 offset:32768
  v_mfma_f32_16x16x32_bf16 v[24:27], v[60:63], a[172:175], v[24:27]
  buffer_load_ushort v8, v201, s[36:39], s58 offen offset:0
  v_mfma_f32_16x16x32_bf16 v[44:47], a[160:163], a[160:163], v[44:47]
  ds_read_b128 a[180:183], v220 offset:32768
  v_mfma_f32_16x16x32_bf16 v[48:51], v[4:7], a[160:163], v[48:51]
  buffer_load_ushort v9, v201, s[36:39], s58 offen offset:32
  v_mfma_f32_16x16x32_bf16 v[52:55], v[60:63], v[4:7], v[52:55]
  ds_read_b128 a[184:187], v216 offset:32768
  v_mfma_f32_16x16x32_bf16 v[28:31], v[68:71], a[160:163], v[28:31]
  ds_read_b128 a[188:191], v212 offset:32768
  v_mfma_f32_16x16x32_bf16 v[32:35], v[68:71], a[164:167], v[32:35]
  ds_read_b64_tr_b16 v[72:73], v209 offset:12288
  v_mfma_f32_16x16x32_bf16 v[36:39], v[68:71], a[168:171], v[36:39]
  ds_read_b64_tr_b16 v[74:75], v209 offset:14336
  v_mfma_f32_16x16x32_bf16 v[40:43], v[68:71], a[172:175], v[40:43]
  v_mfma_f32_16x16x32_bf16 v[56:59], v[68:71], v[4:7], v[56:59]
  s_waitcnt vmcnt(8)
  s_barrier
  s_waitcnt lgkmcnt(0)
  v_mfma_f32_16x16x32_bf16 v[12:15], v[64:67], a[176:179], v[12:15]
  ds_read_b64_tr_b16 v[60:61], v209 offset:49152
  v_mfma_f32_16x16x32_bf16 v[16:19], v[64:67], a[180:183], v[16:19]
  buffer_load_ushort v10, v201, s[36:39], s58 offen offset:64
  v_mfma_f32_16x16x32_bf16 v[20:23], v[64:67], a[184:187], v[20:23]
  ds_read_b64_tr_b16 v[62:63], v209 offset:51200
  v_mfma_f32_16x16x32_bf16 v[24:27], v[64:67], a[188:191], v[24:27]
  buffer_load_ushort v11, v201, s[36:39], s58 offen offset:96
  v_mfma_f32_16x16x32_bf16 v[44:47], a[176:179], a[176:179], v[44:47]
  ds_read_b128 a[192:195], v227 offset:49152
  v_mfma_f32_16x16x32_bf16 v[48:51], v[4:7], a[176:179], v[48:51]
  ds_read_b128 a[196:199], v223 offset:49152
  v_mfma_f32_16x16x32_bf16 v[52:55], v[64:67], v[4:7], v[52:55]
  ds_read_b128 a[200:203], v219 offset:49152
  v_mfma_f32_16x16x32_bf16 v[28:31], v[72:75], a[176:179], v[28:31]
  ds_read_b128 a[204:207], v215 offset:49152
  v_mfma_f32_16x16x32_bf16 v[32:35], v[72:75], a[180:183], v[32:35]
  ds_read_b64_tr_b16 v[68:69], v209 offset:16384
  v_mfma_f32_16x16x32_bf16 v[36:39], v[72:75], a[184:187], v[36:39]
  ds_read_b64_tr_b16 v[70:71], v209 offset:18432
  v_mfma_f32_16x16x32_bf16 v[40:43], v[72:75], a[188:191], v[40:43]
  v_mfma_f32_16x16x32_bf16 v[56:59], v[72:75], v[4:7], v[56:59]
  s_waitcnt vmcnt(8)
  s_barrier
  s_waitcnt lgkmcnt(0)
  v_mfma_f32_16x16x32_bf16 v[12:15], v[60:63], a[192:195], v[12:15]
  ds_read_b64_tr_b16 v[64:65], v209 offset:53248
  s_mul_i32 s58, s49, 224
  v_mfma_f32_16x16x32_bf16 v[16:19], v[60:63], a[196:199], v[16:19]
  ds_read_b64_tr_b16 v[66:67], v209 offset:55296
  buffer_load_dwordx2 v[190:191], v186, s[40:43], s58 offen
  v_mfma_f32_16x16x32_bf16 v[20:23], v[60:63], a[200:203], v[20:23]
  ds_read_b128 a[208:211], v226 offset:49152
  v_mfma_f32_16x16x32_bf16 v[24:27], v[60:63], a[204:207], v[24:27]
  s_lshl_b32 s58, s5, 7
  v_mfma_f32_16x16x32_bf16 v[44:47], a[192:195], a[192:195], v[44:47]
  ds_read_b128 a[212:215], v222 offset:49152
  v_mfma_f32_16x16x32_bf16 v[48:51], v[4:7], a[192:195], v[48:51]
  buffer_load_dwordx2 v[188:189], v185, s[44:47], s58 offen
  v_mfma_f32_16x16x32_bf16 v[52:55], v[60:63], v[4:7], v[52:55]
  ds_read_b128 a[216:219], v218 offset:49152
  v_mfma_f32_16x16x32_bf16 v[28:31], v[68:71], a[192:195], v[28:31]
  ds_read_b128 a[220:223], v214 offset:49152
  v_mfma_f32_16x16x32_bf16 v[32:35], v[68:71], a[196:199], v[32:35]
  ds_read_b64_tr_b16 v[72:73], v209 offset:20480
  v_mfma_f32_16x16x32_bf16 v[36:39], v[68:71], a[200:203], v[36:39]
  ds_read_b64_tr_b16 v[74:75], v209 offset:22528
  v_mfma_f32_16x16x32_bf16 v[40:43], v[68:71], a[204:207], v[40:43]
  v_mfma_f32_16x16x32_bf16 v[56:59], v[68:71], v[4:7], v[56:59]
  s_waitcnt vmcnt(8)
  s_barrier
  s_waitcnt lgkmcnt(0)
  v_mfma_f32_16x16x32_bf16 v[12:15], v[64:67], a[208:211], v[12:15]
  ds_read_b64_tr_b16 v[60:61], v209 offset:57344
  v_mul_u32_u24 v251, 1024, v0
  v_mfma_f32_16x16x32_bf16 v[16:19], v[64:67], a[212:215], v[16:19]
  ds_read_b64_tr_b16 v[62:63], v209 offset:59392
  s_lshr_b32 s58, s2, 3
  v_mfma_f32_16x16x32_bf16 v[20:23], v[64:67], a[216:219], v[20:23]
  ds_read_b128 a[224:227], v225 offset:49152
  s_lshl2_add_u32 s58, s58, s3
  v_mfma_f32_16x16x32_bf16 v[24:27], v[64:67], a[220:223], v[24:27]
  ds_read_b128 a[228:231], v221 offset:49152
  s_mul_i32 s58, s58, 4096
  v_mfma_f32_16x16x32_bf16 v[44:47], a[208:211], a[208:211], v[44:47]
  ds_read_b128 a[232:235], v217 offset:49152
  s_sub_u32 s59, 384, s16
  v_mfma_f32_16x16x32_bf16 v[48:51], v[4:7], a[208:211], v[48:51]
  ds_read_b128 a[236:239], v213 offset:49152
  s_and_b32 s59, s59, 896
  v_mfma_f32_16x16x32_bf16 v[52:55], v[64:67], v[4:7], v[52:55]
  ds_read_b64_tr_b16 v[68:69], v209 offset:24576
  s_add_u32 s58, s58, s59
  v_mfma_f32_16x16x32_bf16 v[28:31], v[72:75], a[208:211], v[28:31]
  ds_read_b64_tr_b16 v[70:71], v209 offset:26624
  s_mov_b64 exec, 0xf
  buffer_load_dword v250, v251, s[16:19], s58 offen offset:0
  s_mov_b64 exec, -1
  v_mfma_f32_16x16x32_bf16 v[32:35], v[72:75], a[212:215], v[32:35]
  s_lshl2_add_u32 s58, s2, s3
  s_mul_i32 s58, s58, 512
  v_mfma_f32_16x16x32_bf16 v[36:39], v[72:75], a[216:219], v[36:39]
  s_mov_b64 exec, 0xf
  buffer_load_dword v250, v228, s[16:19], s58 offen
  s_mov_b64 exec, -1
  v_mfma_f32_16x16x32_bf16 v[40:43], v[72:75], a[220:223], v[40:43]
  v_mfma_f32_16x16x32_bf16 v[56:59], v[72:75], v[4:7], v[56:59]
  s_waitcnt vmcnt(8)
  s_barrier
  s_waitcnt lgkmcnt(0)
  v_mfma_f32_16x16x32_bf16 v[12:15], v[60:63], a[224:227], v[12:15]
  ds_read_b64_tr_b16 v[64:65], v209 offset:61440
  s_lshl2_add_u32 s58, s2, s3
  v_mfma_f32_16x16x32_bf16 v[16:19], v[60:63], a[228:231], v[16:19]
  ds_read_b64_tr_b16 v[66:67], v209 offset:63488
  s_mul_i32 s58, s58, 1792
  v_mfma_f32_16x16x32_bf16 v[20:23], v[60:63], a[232:235], v[20:23]
  ds_read_b128 a[240:243], v224 offset:49152
  s_mov_b64 exec, 0x3fff
  buffer_load_dword v250, v228, s[20:23], s58 offen
  s_mov_b64 exec, -1
  v_mfma_f32_16x16x32_bf16 v[24:27], v[60:63], a[236:239], v[24:27]
  ds_read_b128 a[244:247], v220 offset:49152
  s_sub_u32 s79, s79, 1024
  v_mfma_f32_16x16x32_bf16 v[44:47], a[224:227], a[224:227], v[44:47]
  ds_read_b128 a[248:251], v216 offset:49152
  s_add_u32 m0, s74, 0
  v_mfma_f32_16x16x32_bf16 v[48:51], v[4:7], a[224:227], v[48:51]
  ds_read_b128 a[252:255], v212 offset:49152
  v_mfma_f32_16x16x32_bf16 v[52:55], v[60:63], v[4:7], v[52:55]
  s_add_u32 s61, s79, s83
  v_mfma_f32_16x16x32_bf16 v[28:31], v[68:71], a[224:227], v[28:31]
  ds_read_b64_tr_b16 v[72:73], v209 offset:28672
  v_mfma_f32_16x16x32_bf16 v[32:35], v[68:71], a[228:231], v[32:35]
  buffer_load_dwordx4 v231, s[12:15], s61 offen lds
  v_mfma_f32_16x16x32_bf16 v[36:39], v[68:71], a[232:235], v[36:39]
  ds_read_b64_tr_b16 v[74:75], v209 offset:30720
  v_mfma_f32_16x16x32_bf16 v[40:43], v[68:71], a[236:239], v[40:43]
  v_mfma_f32_16x16x32_bf16 v[56:59], v[68:71], v[4:7], v[56:59]
  s_waitcnt lgkmcnt(0)
  v_mfma_f32_16x16x32_bf16 v[44:47], a[240:243], a[240:243], v[44:47]
  s_add_u32 m0, s74, 4096
  s_add_u32 s61, s79, s84
  v_mfma_f32_16x16x32_bf16 v[48:51], v[4:7], a[240:243], v[48:51]
  buffer_load_dwordx4 v231, s[12:15], s61 offen lds
  v_mfma_f32_16x16x32_bf16 v[12:15], v[64:67], a[240:243], v[12:15]
  s_add_u32 m0, s74, 8192
  v_mfma_f32_16x16x32_bf16 v[16:19], v[64:67], a[244:247], v[16:19]
  s_add_u32 s61, s79, s85
  v_mfma_f32_16x16x32_bf16 v[20:23], v[64:67], a[248:251], v[20:23]
  buffer_load_dwordx4 v231, s[12:15], s61 offen lds
  v_mfma_f32_16x16x32_bf16 v[24:27], v[64:67], a[252:255], v[24:27]
  v_cndmask_b32 v255, v44, v45, s[62:63]
  v_mul_f32 v254, 989855744, v48
  v_cndmask_b32 v255, v255, v46, s[64:65]
  v_mfma_f32_16x16x32_bf16 v[52:55], v[64:67], v[4:7], v[52:55]
  v_cndmask_b32 v255, v255, v47, s[66:67]
  v_mul_f32 v253, v254, v254
  v_mfma_f32_16x16x32_bf16 v[28:31], v[72:75], a[240:243], v[28:31]
  v_mov_b32 v252, 989855744
  v_fma_f32 v255, v255, v252, -v253
  v_mfma_f32_16x16x32_bf16 v[32:35], v[72:75], a[244:247], v[32:35]
  v_max_f32_e64 v255, 0, v255
  v_add_f32 v255, 925353388, v255
  v_mfma_f32_16x16x32_bf16 v[36:39], v[72:75], a[248:251], v[36:39]
  v_rsq_f32_e64 v44, v255
  v_xor_b32 v253, 256, v193
  v_mfma_f32_16x16x32_bf16 v[40:43], v[72:75], a[252:255], v[40:43]
  v_mul_f32 v45, -v254, v44
  s_mov_b64 exec, s[88:89]
  ds_write_b64 v193, v[44:45]
  s_mov_b64 exec, -1
  v_mfma_f32_16x16x32_bf16 v[56:59], v[72:75], v[4:7], v[56:59]
  v_xor_b32 v254, 128, v193
  v_xor_b32 v252, 384, v193
  s_waitcnt lgkmcnt(0)
  s_add_u32 m0, s74, 12288
  s_add_u32 s61, s79, s86
  buffer_load_dwordx4 v231, s[12:15], s61 offen lds
  s_barrier
  ds_read_b64 v[234:235], v193
  ds_read_b64 v[232:233], v254
  ds_read_b64 v[226:227], v253
  ds_read_b64 v[224:225], v252
  s_waitcnt vmcnt(9)
  v_lshl_or_b32 v222, v9, 16, v8
  v_lshl_or_b32 v223, v11, 16, v10
  s_waitcnt lgkmcnt(0)
  s_nop 0
  s_nop 0
  s_nop 0
  v_pk_mul_f32 v[120:121], v[52:53], v[234:235] op_sel:[0,1] op_sel_hi:[1,1]
  v_pk_mul_f32 v[124:125], v[52:53], v[232:233] op_sel:[0,1] op_sel_hi:[1,1]
  v_pk_mul_f32 v[128:129], v[52:53], v[226:227] op_sel:[0,1] op_sel_hi:[1,1]
  v_pk_mul_f32 v[132:133], v[52:53], v[224:225] op_sel:[0,1] op_sel_hi:[1,1]
  v_pk_mul_f32 v[122:123], v[54:55], v[234:235] op_sel:[0,1] op_sel_hi:[1,1]
  v_pk_mul_f32 v[126:127], v[54:55], v[232:233] op_sel:[0,1] op_sel_hi:[1,1]
  v_pk_mul_f32 v[130:131], v[54:55], v[226:227] op_sel:[0,1] op_sel_hi:[1,1]
  v_pk_mul_f32 v[134:135], v[54:55], v[224:225] op_sel:[0,1] op_sel_hi:[1,1]
  v_pk_fma_f32 v[12:13], v[12:13], v[234:235], v[120:121] op_sel:[0,0,0] op_sel_hi:[1,0,1]
  v_pk_fma_f32 v[16:17], v[16:17], v[232:233], v[124:125] op_sel:[0,0,0] op_sel_hi:[1,0,1]
  s_sub_u32 s80, s80, 1024
  s_add_u32 m0, s74, 16384
  s_add_u32 s61, s80, s83
  buffer_load_dwordx4 v231, s[12:15], s61 offen lds
  s_nop 0
  v_pk_fma_f32 v[20:21], v[20:21], v[226:227], v[128:129] op_sel:[0,0,0] op_sel_hi:[1,0,1]
  v_pk_fma_f32 v[24:25], v[24:25], v[224:225], v[132:133] op_sel:[0,0,0] op_sel_hi:[1,0,1]
  v_pk_fma_f32 v[14:15], v[14:15], v[234:235], v[122:123] op_sel:[0,0,0] op_sel_hi:[1,0,1]
  v_pk_fma_f32 v[18:19], v[18:19], v[232:233], v[126:127] op_sel:[0,0,0] op_sel_hi:[1,0,1]
  v_pk_fma_f32 v[22:23], v[22:23], v[226:227], v[130:131] op_sel:[0,0,0] op_sel_hi:[1,0,1]
  v_pk_fma_f32 v[26:27], v[26:27], v[224:225], v[134:135] op_sel:[0,0,0] op_sel_hi:[1,0,1]
  v_cvt_pk_bf16_f32 v220, v12, v13
  v_cvt_pk_bf16_f32 v218, v16, v17
  v_cvt_pk_bf16_f32 v216, v20, v21
  v_cvt_pk_bf16_f32 v214, v24, v25
  v_cvt_pk_bf16_f32 v221, v14, v15
  v_cvt_pk_bf16_f32 v219, v18, v19
  v_cvt_pk_bf16_f32 v217, v22, v23
  v_cvt_pk_bf16_f32 v215, v26, v27
  v_mfma_f32_16x16x16_bf16 v[12:15], v[222:223], v[220:221], 0
  v_mfma_f32_16x16x16_bf16 v[16:19], v[222:223], v[218:219], 0
  s_add_u32 m0, s74, 20480
  s_add_u32 s61, s80, s84
  buffer_load_dwordx4 v231, s[12:15], s61 offen lds
  v_mfma_f32_16x16x16_bf16 v[20:23], v[222:223], v[216:217], 0
  v_mfma_f32_16x16x16_bf16 v[24:27], v[222:223], v[214:215], 0
  s_nop 0
  s_nop 0
  s_nop 0
  v_pk_mul_f32 v[120:121], v[56:57], v[234:235] op_sel:[0,1] op_sel_hi:[1,1]
  v_pk_mul_f32 v[124:125], v[56:57], v[232:233] op_sel:[0,1] op_sel_hi:[1,1]
  v_pk_mul_f32 v[128:129], v[56:57], v[226:227] op_sel:[0,1] op_sel_hi:[1,1]
  v_pk_mul_f32 v[132:133], v[56:57], v[224:225] op_sel:[0,1] op_sel_hi:[1,1]
  v_pk_mul_f32 v[122:123], v[58:59], v[234:235] op_sel:[0,1] op_sel_hi:[1,1]
  v_pk_mul_f32 v[126:127], v[58:59], v[232:233] op_sel:[0,1] op_sel_hi:[1,1]
  v_pk_mul_f32 v[130:131], v[58:59], v[226:227] op_sel:[0,1] op_sel_hi:[1,1]
  v_pk_mul_f32 v[134:135], v[58:59], v[224:225] op_sel:[0,1] op_sel_hi:[1,1]
  s_add_u32 m0, s74, 24576
  s_add_u32 s61, s80, s85
  buffer_load_dwordx4 v231, s[12:15], s61 offen lds
  s_nop 0
  v_pk_fma_f32 v[28:29], v[28:29], v[234:235], v[120:121] op_sel:[0,0,0] op_sel_hi:[1,0,1]
  v_pk_fma_f32 v[32:33], v[32:33], v[232:233], v[124:125] op_sel:[0,0,0] op_sel_hi:[1,0,1]
  v_pk_fma_f32 v[36:37], v[36:37], v[226:227], v[128:129] op_sel:[0,0,0] op_sel_hi:[1,0,1]
  v_pk_fma_f32 v[40:41], v[40:41], v[224:225], v[132:133] op_sel:[0,0,0] op_sel_hi:[1,0,1]
  v_pk_fma_f32 v[30:31], v[30:31], v[234:235], v[122:123] op_sel:[0,0,0] op_sel_hi:[1,0,1]
  v_pk_fma_f32 v[34:35], v[34:35], v[232:233], v[126:127] op_sel:[0,0,0] op_sel_hi:[1,0,1]
  v_pk_fma_f32 v[38:39], v[38:39], v[226:227], v[130:131] op_sel:[0,0,0] op_sel_hi:[1,0,1]
  v_pk_fma_f32 v[42:43], v[42:43], v[224:225], v[134:135] op_sel:[0,0,0] op_sel_hi:[1,0,1]
  v_cvt_pk_bf16_f32 v220, v28, v29
  v_cvt_pk_bf16_f32 v218, v32, v33
  v_cvt_pk_bf16_f32 v216, v36, v37
  v_cvt_pk_bf16_f32 v214, v40, v41
  v_cvt_pk_bf16_f32 v221, v30, v31
  v_cvt_pk_bf16_f32 v219, v34, v35
  v_cvt_pk_bf16_f32 v217, v38, v39
  v_cvt_pk_bf16_f32 v215, v42, v43
  v_mfma_f32_16x16x16_bf16 v[28:31], v[220:221], v[206:207], 0
  s_add_u32 m0, s74, 28672
  s_add_u32 s61, s80, s86
  buffer_load_dwordx4 v231, s[12:15], s61 offen lds
  v_mfma_f32_16x16x16_bf16 v[32:35], v[218:219], v[206:207], 0
  v_mfma_f32_16x16x16_bf16 v[36:39], v[216:217], v[206:207], 0
  v_mfma_f32_16x16x16_bf16 v[40:43], v[214:215], v[206:207], 0
  v_max3_f32 v220, v12, v13, v14
  v_max3_f32 v218, v16, v17, v18
  v_max3_f32 v216, v20, v21, v22
  v_max3_f32 v214, v24, v25, v26
  v_max3_f32 v221, -v12, -v13, -v14
  s_sub_u32 s81, s81, 1024
  s_add_u32 m0, s74, 32768
  s_add_u32 s61, s81, s83
  buffer_load_dwordx4 v231, s[12:15], s61 offen lds
  v_max3_f32 v219, -v16, -v17, -v18
  v_max3_f32 v217, -v20, -v21, -v22
  v_max3_f32 v215, -v24, -v25, -v26
  v_max_f32 v220, v220, v15
  v_max_f32 v218, v218, v19
  v_max_f32 v216, v216, v23
  v_max_f32 v214, v214, v27
  v_max_f32_e64 v221, v221, -v15
  v_max_f32_e64 v219, v219, -v19
  v_max_f32_e64 v217, v217, -v23
  v_max_f32_e64 v215, v215, -v27
  v_permlane32_swap_b32 v220, v221
  v_permlane32_swap_b32 v216, v217
  v_permlane32_swap_b32 v218, v219
  v_permlane32_swap_b32 v214, v215
  s_add_u32 m0, s74, 36864
  s_add_u32 s61, s81, s84
  buffer_load_dwordx4 v231, s[12:15], s61 offen lds
  v_max_f32 v220, v220, v221
  v_max_f32 v216, v216, v217
  v_max_f32 v218, v218, v219
  v_max_f32 v214, v214, v215
  s_nop 0
  v_permlane16_swap_b32 v220, v218
  v_permlane16_swap_b32 v216, v214
  v_max_f32 v220, v220, v218
  v_max_f32 v216, v216, v214
  v_mul_f32 v220, s69, v220
  v_mul_f32 v216, s69, v216
  v_mov_b32 v218, v220
  v_mov_b32 v214, v216
  s_nop 0
  v_permlane16_swap_b32 v220, v218
  v_permlane16_swap_b32 v216, v214
  v_mov_b32 v221, v220
  s_add_u32 m0, s74, 40960
  s_add_u32 s61, s81, s85
  buffer_load_dwordx4 v231, s[12:15], s61 offen lds
  v_mov_b32 v217, v216
  v_mov_b32 v219, v218
  v_mov_b32 v215, v214
  v_permlane32_swap_b32 v220, v221
  v_permlane32_swap_b32 v216, v217
  v_permlane32_swap_b32 v218, v219
  v_permlane32_swap_b32 v214, v215
  v_cvt_pk_bf16_f32 v112, v28, v29
  v_cvt_pk_bf16_f32 v113, v30, v31
  v_cvt_pk_bf16_f32 v114, v32, v33
  v_cvt_pk_bf16_f32 v115, v34, v35
  v_cvt_pk_bf16_f32 v116, v36, v37
  v_cvt_pk_bf16_f32 v117, v38, v39
  v_cvt_pk_bf16_f32 v118, v40, v41
  s_add_u32 m0, s74, 45056
  s_add_u32 s61, s81, s86
  buffer_load_dwordx4 v231, s[12:15], s61 offen lds
  s_nop 0
  v_cvt_pk_bf16_f32 v119, v42, v43
  s_nop 0
  s_nop 0
  v_pk_fma_f32 v[56:57], v[12:13], s[68:69], v[220:221] op_sel:[0,1,1] op_sel_hi:[1,1,1]
  v_pk_fma_f32 v[120:121], v[16:17], s[68:69], v[218:219] op_sel:[0,1,1] op_sel_hi:[1,1,1]
  v_pk_fma_f32 v[124:125], v[20:21], s[68:69], v[216:217] op_sel:[0,1,1] op_sel_hi:[1,1,1]
  v_pk_fma_f32 v[128:129], v[24:25], s[68:69], v[214:215] op_sel:[0,1,1] op_sel_hi:[1,1,1]
  v_pk_fma_f32 v[12:13], v[12:13], s[68:69], v[220:221] op_sel:[0,0,0] op_sel_hi:[1,0,0]
  v_pk_fma_f32 v[16:17], v[16:17], s[68:69], v[218:219] op_sel:[0,0,0] op_sel_hi:[1,0,0]
  v_pk_fma_f32 v[20:21], v[20:21], s[68:69], v[216:217] op_sel:[0,0,0] op_sel_hi:[1,0,0]
  v_pk_fma_f32 v[24:25], v[24:25], s[68:69], v[214:215] op_sel:[0,0,0] op_sel_hi:[1,0,0]
  v_pk_fma_f32 v[58:59], v[14:15], s[68:69], v[220:221] op_sel:[0,1,1] op_sel_hi:[1,1,1]
  v_pk_fma_f32 v[122:123], v[18:19], s[68:69], v[218:219] op_sel:[0,1,1] op_sel_hi:[1,1,1]
  v_pk_fma_f32 v[126:127], v[22:23], s[68:69], v[216:217] op_sel:[0,1,1] op_sel_hi:[1,1,1]
  v_pk_fma_f32 v[130:131], v[26:27], s[68:69], v[214:215] op_sel:[0,1,1] op_sel_hi:[1,1,1]
  v_pk_fma_f32 v[14:15], v[14:15], s[68:69], v[220:221] op_sel:[0,0,0] op_sel_hi:[1,0,0]
  v_pk_fma_f32 v[18:19], v[18:19], s[68:69], v[218:219] op_sel:[0,0,0] op_sel_hi:[1,0,0]
  v_pk_fma_f32 v[22:23], v[22:23], s[68:69], v[216:217] op_sel:[0,0,0] op_sel_hi:[1,0,0]
  v_pk_fma_f32 v[26:27], v[26:27], s[68:69], v[214:215] op_sel:[0,0,0] op_sel_hi:[1,0,0]
  v_exp_f32_e64 v12, v12
  s_sub_u32 s82, s82, 1024
  s_add_u32 m0, s74, 49152
  s_add_u32 s61, s82, s83
  buffer_load_dwordx4 v231, s[12:15], s61 offen lds
  v_exp_f32 v16, v16
  v_exp_f32 v20, v20
  v_exp_f32 v24, v24
  v_exp_f32 v56, v56
  v_exp_f32 v120, v120
  v_exp_f32 v124, v124
  v_exp_f32 v128, v128
  v_exp_f32 v13, v13
  v_exp_f32 v17, v17
  v_exp_f32_e64 v21, v21
  s_add_u32 m0, s74, 53248
  s_add_u32 s61, s82, s84
  buffer_load_dwordx4 v231, s[12:15], s61 offen lds
  v_exp_f32 v25, v25
  v_exp_f32 v57, v57
  v_exp_f32 v121, v121
  v_exp_f32 v125, v125
  v_exp_f32 v129, v129
  v_exp_f32 v14, v14
  v_exp_f32 v18, v18
  v_exp_f32 v22, v22
  v_exp_f32 v26, v26
  s_add_u32 m0, s74, 57344
  s_add_u32 s61, s82, s85
  buffer_load_dwordx4 v231, s[12:15], s61 offen lds
  v_exp_f32 v58, v58
  v_exp_f32 v122, v122
  v_exp_f32 v126, v126
  v_exp_f32 v130, v130
  v_exp_f32 v15, v15
  v_exp_f32 v19, v19
  v_exp_f32 v23, v23
  v_exp_f32 v27, v27
  v_exp_f32 v59, v59
  s_add_u32 m0, s74, 61440
  s_add_u32 s61, s82, s86
  buffer_load_dwordx4 v231, s[12:15], s61 offen lds
  v_exp_f32 v123, v123
  v_exp_f32 v127, v127
  v_exp_f32 v131, v131
  v_pk_add_f32 v[132:133], v[12:13], v[14:15]
  v_pk_add_f32 v[136:137], v[16:17], v[18:19]
  v_pk_add_f32 v[140:141], v[20:21], v[22:23]
  v_pk_add_f32 v[144:145], v[24:25], v[26:27]
  v_pk_add_f32 v[134:135], v[56:57], v[58:59]
  v_pk_add_f32 v[138:139], v[120:121], v[122:123]
  v_pk_add_f32 v[142:143], v[124:125], v[126:127]
  v_pk_add_f32 v[146:147], v[128:129], v[130:131]
  v_add_f32 v220, v132, v133
  v_add_f32 v218, v136, v137
  v_add_f32 v216, v140, v141
  v_add_f32 v214, v144, v145
  v_add_f32_e64 v221, v134, v135
  s_lshl4_add_u32 s58, s50, s49
  s_lshl_b32 s58, s58, 7
  s_add_u32 s58, s58, 32768
  s_cmp_lg_u32 s3, 3
  s_cbranch_scc1 L_xcc_1
  s_mov_b64 exec, 1
  buffer_store_dwordx2 v[202:203], off, s[28:31], s58 sc1
  s_mov_b64 exec, -1
L_xcc_1:
  v_add_f32 v219, v138, v139
  v_add_f32 v217, v142, v143
  v_add_f32 v215, v146, v147
  v_permlane32_swap_b32 v220, v221
  v_permlane32_swap_b32 v216, v217
  v_permlane32_swap_b32 v218, v219
  v_permlane32_swap_b32 v214, v215
  v_add_f32 v220, v220, v221
  v_add_f32 v216, v216, v217
  v_add_f32 v218, v218, v219
  v_add_f32 v214, v214, v215
  s_nop 0
  v_permlane16_swap_b32 v220, v218
  v_permlane16_swap_b32 v216, v214
  s_add_u32 m0, s71, 86016
  s_lshl_b32 s58, s5, 7
  s_add_u32 s58, s58, s70
  buffer_load_dwordx4 v200, s[8:11], s58 offen lds
  v_add_f32 v220, v220, v218
  v_add_f32 v216, v216, v214
  v_rcp_f32 v220, v220
  v_rcp_f32 v216, v216
  v_mov_b32 v218, v220
  v_mov_b32 v214, v216
  s_nop 0
  v_permlane16_swap_b32 v220, v218
  v_permlane16_swap_b32 v216, v214
  v_mov_b32 v221, v220
  v_mov_b32 v217, v216
  v_mov_b32 v219, v218
  v_mov_b32_e64 v215, v214
  v_permlane32_swap_b32 v220, v221
  v_permlane32_swap_b32 v216, v217
  s_add_u32 s58, s58, 7168
  buffer_load_dwordx4 v200, s[8:11], s58 offen offset:1024 lds
  v_permlane32_swap_b32 v218, v219
  v_permlane32_swap_b32 v214, v215
  s_nop 0
  s_nop 0
  v_pk_mul_f32 v[12:13], v[12:13], v[220:221] op_sel:[0,0] op_sel_hi:[1,0]
  v_pk_mul_f32 v[16:17], v[16:17], v[218:219] op_sel:[0,0] op_sel_hi:[1,0]
  v_pk_mul_f32 v[20:21], v[20:21], v[216:217] op_sel:[0,0] op_sel_hi:[1,0]
  v_pk_mul_f32 v[24:25], v[24:25], v[214:215] op_sel:[0,0] op_sel_hi:[1,0]
  v_pk_mul_f32 v[14:15], v[14:15], v[220:221] op_sel:[0,0] op_sel_hi:[1,0]
  v_pk_mul_f32 v[18:19], v[18:19], v[218:219] op_sel:[0,0] op_sel_hi:[1,0]
  v_pk_mul_f32 v[22:23], v[22:23], v[216:217] op_sel:[0,0] op_sel_hi:[1,0]
  v_pk_mul_f32 v[26:27], v[26:27], v[214:215] op_sel:[0,0] op_sel_hi:[1,0]
  v_pk_mul_f32 v[56:57], v[56:57], v[220:221] op_sel:[0,1] op_sel_hi:[1,1]
  v_pk_mul_f32 v[120:121], v[120:121], v[218:219] op_sel:[0,1] op_sel_hi:[1,1]
  v_pk_mul_f32 v[124:125], v[124:125], v[216:217] op_sel:[0,1] op_sel_hi:[1,1]
  v_pk_mul_f32 v[128:129], v[128:129], v[214:215] op_sel:[0,1] op_sel_hi:[1,1]
  v_pk_mul_f32 v[58:59], v[58:59], v[220:221] op_sel:[0,1] op_sel_hi:[1,1]
  s_add_u32 s59, s92, 0
  s_and_b32 s59, s59, 3
  s_lshl2_add_u32 s59, s3, s59
  s_lshl_b32 s60, s59, 8
  s_lshl_b32 s59, s59, 12
  s_add_u32 m0, s59, 98304
  s_add_u32 s60, s60, s5
  s_lshl_b32 s60, s60, 7
  buffer_load_dwordx4 v243, s[16:19], s60 offen offset:0 lds
  s_nop 0
  v_pk_mul_f32 v[122:123], v[122:123], v[218:219] op_sel:[0,1] op_sel_hi:[1,1]
  v_pk_mul_f32 v[126:127], v[126:127], v[216:217] op_sel:[0,1] op_sel_hi:[1,1]
  v_pk_mul_f32 v[130:131], v[130:131], v[214:215] op_sel:[0,1] op_sel_hi:[1,1]
  v_cvt_pk_bf16_f32 v8, v12, v13
  v_cvt_pk_bf16_f32 v44, v16, v17
  v_cvt_pk_bf16_f32 v48, v20, v21
  v_cvt_pk_bf16_f32 v76, v24, v25
  v_cvt_pk_bf16_f32 v9, v14, v15
  v_cvt_pk_bf16_f32 v45, v18, v19
  v_cvt_pk_bf16_f32 v49, v22, v23
  v_cvt_pk_bf16_f32 v77, v26, v27
  v_cvt_pk_bf16_f32 v10, v56, v57
  v_cvt_pk_bf16_f32 v46, v120, v121
  v_cvt_pk_bf16_f32 v50, v124, v125
  v_cvt_pk_bf16_f32 v78, v128, v129
  v_cvt_pk_bf16_f32 v11, v58, v59
  v_cvt_pk_bf16_f32 v47, v122, v123
  v_cvt_pk_bf16_f32 v51, v126, v127
  v_cvt_pk_bf16_f32 v79, v130, v131
  buffer_load_dwordx4 v242, s[16:19], s60 offen offset:1024 lds
  v_mfma_f32_16x16x16_bf16 v[12:15], v[8:9], v[206:207], 0
  v_mfma_f32_16x16x16_bf16 v[16:19], v[44:45], v[206:207], 0
  v_mfma_f32_16x16x16_bf16 v[20:23], v[48:49], v[206:207], 0
  v_mfma_f32_16x16x16_bf16 v[24:27], v[76:77], v[206:207], 0
  v_mfma_f32_16x16x16_bf16 v[80:83], v[10:11], v[206:207], 0
  v_mfma_f32_16x16x16_bf16 v[84:87], v[46:47], v[206:207], 0
  v_mfma_f32_16x16x16_bf16 v[88:91], v[50:51], v[206:207], 0
  s_nop 1
  v_cvt_pk_bf16_f32 v96, v12, v13
  v_cvt_pk_bf16_f32 v97, v14, v15
  v_mfma_f32_16x16x16_bf16 v[92:95], v[78:79], v[206:207], 0
  s_nop 0
  v_cvt_pk_bf16_f32 v98, v16, v17
  v_cvt_pk_bf16_f32 v99, v18, v19
  v_cvt_pk_bf16_f32 v100, v20, v21
  v_cvt_pk_bf16_f32 v101, v22, v23
  v_cvt_pk_bf16_f32 v102, v24, v25
  v_cvt_pk_bf16_f32 v103, v26, v27
  v_cvt_pk_bf16_f32 v104, v80, v81
  v_cvt_pk_bf16_f32 v105, v82, v83
  v_cvt_pk_bf16_f32 v106, v84, v85
  v_cvt_pk_bf16_f32 v107, v86, v87
  v_cvt_pk_bf16_f32 v108, v88, v89
  v_cvt_pk_bf16_f32 v109, v90, v91
  v_cvt_pk_bf16_f32 v110, v92, v93
  v_cvt_pk_bf16_f32 v111, v94, v95
  v_mfma_f32_16x16x32_bf16 v[20:23], v[96:99], v[4:7], 0
  v_mfma_f32_16x16x32_bf16 v[24:27], v[104:107], v[4:7], 0
  v_mfma_f32_16x16x32_bf16 v[20:23], v[100:103], v[4:7], v[20:23]
  v_mfma_f32_16x16x32_bf16 v[24:27], v[108:111], v[4:7], v[24:27]
  v_mfma_f32_16x16x32_bf16 v[12:15], v[96:99], v[112:115], 0
  v_mfma_f32_16x16x32_bf16 v[16:19], v[104:107], v[112:115], 0
  v_mfma_f32_16x16x32_bf16 v[12:15], v[100:103], v[116:119], v[12:15]
  v_mfma_f32_16x16x32_bf16 v[16:19], v[108:111], v[116:119], v[16:19]
  s_add_u32 s52, s91, 32768
  v_mov_b32 v83, v245
  v_mov_b32_e64 v87, v245
  s_nop 3
  v_cvt_pk_bf16_f32 v80, v12, v13
  v_cvt_pk_bf16_f32 v84, v16, v17
  v_cvt_pk_bf16_f32 v81, v14, v15
  v_cvt_pk_bf16_f32 v85, v18, v19
  v_cndmask_b32 v82, v20, v21, s[62:63]
  v_cndmask_b32 v86, v24, v25, s[62:63]
  v_cndmask_b32 v82, v82, v22, s[64:65]
  v_cndmask_b32 v86, v86, v26, s[64:65]
  v_cndmask_b32 v82, v82, v23, s[66:67]
  v_cndmask_b32 v86, v86, v27, s[66:67]
  buffer_store_dwordx4 v[80:83], v194, s[28:31], s91 offen sc1
  buffer_store_dwordx4 v[84:87], v194, s[28:31], s52 offen sc1
  s_mov_b32 s40, s3
  s_add_u32 s41, s6, 4096
  s_waitcnt vmcnt(6)
  s_barrier
  s_lshl2_add_u32 s58, s2, s3
  s_mul_i32 s58, s58, 1792
  s_mov_b64 exec, 0x3fff
  buffer_load_dword v250, v228, s[24:27], s58 offen
  s_mov_b64 exec, -1
  ds_read_b64_tr_b16 v[60:61], v210 offset:0
  ds_read_b64_tr_b16 v[62:63], v210 offset:2048
  ds_read_b64_tr_b16 v[64:65], v210 offset:4096
  ds_read_b64_tr_b16 v[66:67], v210 offset:6144
  ds_read_b64_tr_b16 v[68:69], v210 offset:8192
  ds_read_b64_tr_b16 v[70:71], v210 offset:10240
  s_waitcnt lgkmcnt(4)
  v_mfma_f32_16x16x32_bf16 v[12:15], v[60:63], a[0:3], 0
  ds_read_b64_tr_b16 v[72:73], v210 offset:12288
  s_mul_i32 s53, s49, 224
  v_mfma_f32_16x16x32_bf16 v[16:19], v[60:63], a[4:7], 0
  ds_read_b64_tr_b16 v[74:75], v210 offset:14336
  s_mul_i32 s14, s3, 114688
  v_mfma_f32_16x16x32_bf16 v[20:23], v[60:63], a[8:11], 0
  s_add_u32 s14, s14, s53
  s_mul_i32 s13, s3, 7168
  v_mfma_f32_16x16x32_bf16 v[24:27], v[60:63], a[12:15], 0
  s_mul_i32 s15, s3, 12288
  s_add_u32 s15, s15, 114688
  v_mfma_f32_16x16x32_bf16 v[8:11], v[60:63], v[4:7], 0
  s_lshl_b32 s36, s49, 7
  s_waitcnt lgkmcnt(4)
  v_mfma_f32_16x16x32_bf16 v[12:15], v[64:67], a[16:19], v[12:15]
  ds_read_b64_tr_b16 v[60:61], v210 offset:16384
  s_add_u32 s36, s36, s90
  v_mfma_f32_16x16x32_bf16 v[16:19], v[64:67], a[20:23], v[16:19]
  ds_read_b64_tr_b16 v[62:63], v210 offset:18432
  s_mul_i32 s53, s3, 3584
  v_mfma_f32_16x16x32_bf16 v[20:23], v[64:67], a[24:27], v[20:23]
  s_add_u32 s53, s53, s5
  s_lshl_b32 s53, s53, 7
  v_mfma_f32_16x16x32_bf16 v[24:27], v[64:67], a[28:31], v[24:27]
  s_lshl1_add_u32 s51, 0, s2
  s_add_u32 s43, s51, 0
  v_mfma_f32_16x16x32_bf16 v[8:11], v[64:67], v[4:7], v[8:11]
  s_and_b32 s43, s43, 3
  s_waitcnt lgkmcnt(4)
  v_mfma_f32_16x16x32_bf16 v[12:15], v[68:71], a[32:35], v[12:15]
  ds_read_b64_tr_b16 v[64:65], v210 offset:20480
  s_mul_i32 s47, s43, 114688
  v_mfma_f32_16x16x32_bf16 v[16:19], v[68:71], a[36:39], v[16:19]
  ds_read_b64_tr_b16 v[66:67], v210 offset:22528
  s_add_u32 s47, s47, s53
  v_mfma_f32_16x16x32_bf16 v[20:23], v[68:71], a[40:43], v[20:23]
  s_add_u32 s44, s51, 1
  s_and_b32 s44, s44, 3
  v_mfma_f32_16x16x32_bf16 v[24:27], v[68:71], a[44:47], v[24:27]
  s_mul_i32 s62, s44, 114688
  s_add_u32 s62, s62, s53
  v_mfma_f32_16x16x32_bf16 v[8:11], v[68:71], v[4:7], v[8:11]
  s_add_u32 s45, s51, 2
  s_waitcnt lgkmcnt(4)
  v_mfma_f32_16x16x32_bf16 v[12:15], v[72:75], a[48:51], v[12:15]
  ds_read_b64_tr_b16 v[68:69], v210 offset:24576
  s_and_b32 s45, s45, 3
  v_mfma_f32_16x16x32_bf16 v[16:19], v[72:75], a[52:55], v[16:19]
  ds_read_b64_tr_b16 v[70:71], v210 offset:26624
  s_mul_i32 s63, s45, 114688
  v_mfma_f32_16x16x32_bf16 v[20:23], v[72:75], a[56:59], v[20:23]
  s_add_u32 s63, s63, s53
  s_add_u32 s46, s51, 3
  v_mfma_f32_16x16x32_bf16 v[24:27], v[72:75], a[60:63], v[24:27]
  s_and_b32 s46, s46, 3
  s_mul_i32 s64, s46, 114688
  v_mfma_f32_16x16x32_bf16 v[8:11], v[72:75], v[4:7], v[8:11]
  s_add_u32 s64, s64, s53
  s_waitcnt lgkmcnt(4)
  v_mfma_f32_16x16x32_bf16 v[12:15], v[60:63], a[64:67], v[12:15]
  ds_read_b64_tr_b16 v[72:73], v210 offset:28672
  s_lshr_b32 s51, s3, 1
  v_mfma_f32_16x16x32_bf16 v[16:19], v[60:63], a[68:71], v[16:19]
  ds_read_b64_tr_b16 v[74:75], v210 offset:30720
  s_lshl_b32 s55, s51, 10
  v_mfma_f32_16x16x32_bf16 v[20:23], v[60:63], a[72:75], v[20:23]
  s_and_b32 s51, s3, 1
  s_lshl3_add_u32 s55, s51, s55
  v_mfma_f32_16x16x32_bf16 v[24:27], v[60:63], a[76:79], v[24:27]
  s_add_u32 s55, s55, s6
  s_xor_b32 s65, s3, 0
  v_mfma_f32_16x16x32_bf16 v[8:11], v[60:63], v[4:7], v[8:11]
  s_lshl_b32 s65, s65, 11
  s_waitcnt lgkmcnt(4)
  v_mfma_f32_16x16x32_bf16 v[12:15], v[64:67], a[80:83], v[12:15]
  ds_read_b64_tr_b16 v[60:61], v210 offset:32768
  s_add_u32 s65, s65, s55
  v_mfma_f32_16x16x32_bf16 v[16:19], v[64:67], a[84:87], v[16:19]
  ds_read_b64_tr_b16 v[62:63], v210 offset:34816
  s_xor_b32 s66, s3, 1
  v_mfma_f32_16x16x32_bf16 v[20:23], v[64:67], a[88:91], v[20:23]
  s_lshl_b32 s66, s66, 11
  s_add_u32 s66, s66, s55
  v_mfma_f32_16x16x32_bf16 v[24:27], v[64:67], a[92:95], v[24:27]
  s_xor_b32 s67, s3, 2
  s_lshl_b32 s67, s67, 11
  v_mfma_f32_16x16x32_bf16 v[8:11], v[64:67], v[4:7], v[8:11]
  s_add_u32 s67, s67, s55
  s_waitcnt lgkmcnt(4)
  v_mfma_f32_16x16x32_bf16 v[12:15], v[68:71], a[96:99], v[12:15]
  ds_read_b64_tr_b16 v[64:65], v210 offset:36864
  s_xor_b32 s72, s3, 3
  v_mfma_f32_16x16x32_bf16 v[16:19], v[68:71], a[100:103], v[16:19]
  ds_read_b64_tr_b16 v[66:67], v210 offset:38912
  s_lshl_b32 s72, s72, 11
  v_mfma_f32_16x16x32_bf16 v[20:23], v[68:71], a[104:107], v[20:23]
  s_add_u32 s72, s72, s55
  s_lshr_b32 s37, s70, 3
  v_mfma_f32_16x16x32_bf16 v[24:27], v[68:71], a[108:111], v[24:27]
  s_add_u32 s37, s37, 2097152
  s_and_b32 s51, s4, 1
  v_mfma_f32_16x16x32_bf16 v[8:11], v[68:71], v[4:7], v[8:11]
  s_lshl2_add_u32 s51, s51, s3
  s_waitcnt lgkmcnt(4)
  v_mfma_f32_16x16x32_bf16 v[12:15], v[72:75], a[112:115], v[12:15]
  ds_read_b64_tr_b16 v[68:69], v210 offset:40960
  s_lshl3_add_u32 s39, s51, s5
  v_mfma_f32_16x16x32_bf16 v[16:19], v[72:75], a[116:119], v[16:19]
  ds_read_b64_tr_b16 v[70:71], v210 offset:43008
  s_lshr_b32 s38, s39, 2
  v_mfma_f32_16x16x32_bf16 v[20:23], v[72:75], a[120:123], v[20:23]
  s_lshl_b32 s38, s38, 3
  s_and_b32 s51, s5, 3
  v_mfma_f32_16x16x32_bf16 v[24:27], v[72:75], a[124:127], v[24:27]
  s_add_u32 s38, s38, s51
  s_lshl_b32 s38, s38, 11
  v_mfma_f32_16x16x32_bf16 v[8:11], v[72:75], v[4:7], v[8:11]
  s_lshl_b32 s39, s39, 7
  s_waitcnt lgkmcnt(4)
  v_mfma_f32_16x16x32_bf16 v[12:15], v[60:63], a[128:131], v[12:15]
  buffer_load_dwordx4 v241, s[16:19], s60 offen offset:2048 lds
  s_add_u32 s39, s39, 262144
  v_mfma_f32_16x16x32_bf16 v[16:19], v[60:63], a[132:135], v[16:19]
  ds_read_b64_tr_b16 v[72:73], v210 offset:45056
  s_lshl_b32 s42, s50, 21
  v_mfma_f32_16x16x32_bf16 v[20:23], v[60:63], a[136:139], v[20:23]
  ds_read_b64_tr_b16 v[74:75], v210 offset:47104
  s_add_u32 s42, s42, 8388608
  v_mfma_f32_16x16x32_bf16 v[24:27], v[60:63], a[140:143], v[24:27]
  s_sub_u32 s51, s15, 98304
  v_lshlrev_b32_e64 v218, 3, v0
  v_mfma_f32_16x16x32_bf16 v[8:11], v[60:63], v[4:7], v[8:11]
  v_lshrrev_b32 v254, 1, v249
  s_waitcnt lgkmcnt(4)
  v_mfma_f32_16x16x32_bf16 v[12:15], v[64:67], a[144:147], v[12:15]
  buffer_load_dwordx4 v240, s[16:19], s60 offen offset:3072 lds
  v_min_u32_e64 v254, 6, v254
  v_mfma_f32_16x16x32_bf16 v[16:19], v[64:67], a[148:151], v[16:19]
  ds_read_b64_tr_b16 v[60:61], v210 offset:49152
  v_lshlrev_b32_e64 v254, 7, v254
  v_mfma_f32_16x16x32_bf16 v[20:23], v[64:67], a[152:155], v[20:23]
  ds_read_b64_tr_b16 v[62:63], v210 offset:51200
  v_lshl_or_b32 v187, v248, 5, v254
  v_mfma_f32_16x16x32_bf16 v[24:27], v[64:67], a[156:159], v[24:27]
  v_add_u32 v187, 125952, v187
  v_lshrrev_b32_e64 v253, 2, v0
  v_mfma_f32_16x16x32_bf16 v[8:11], v[64:67], v[4:7], v[8:11]
  v_mul_u32_u24 v253, 224, v253
  s_waitcnt lgkmcnt(4)
  v_mfma_f32_16x16x32_bf16 v[12:15], v[68:71], a[160:163], v[12:15]
  s_add_u32 s59, s92, 1
  ds_read_b64_tr_b16 v[64:65], v210 offset:53248
  s_and_b32 s59, s59, 3
  v_mfma_f32_16x16x32_bf16 v[16:19], v[68:71], a[164:167], v[16:19]
  ds_read_b64_tr_b16 v[66:67], v210 offset:55296
  s_lshl2_add_u32 s59, s3, s59
  v_mfma_f32_16x16x32_bf16 v[20:23], v[68:71], a[168:171], v[20:23]
  s_lshl_b32 s60, s59, 8
  s_lshl_b32 s59, s59, 12
  v_mfma_f32_16x16x32_bf16 v[24:27], v[68:71], a[172:175], v[24:27]
  s_add_u32 m0, s59, 98304
  s_add_u32 s60, s60, s5
  v_mfma_f32_16x16x32_bf16 v[8:11], v[68:71], v[4:7], v[8:11]
  s_lshl_b32 s60, s60, 7
  buffer_load_dwordx4 v243, s[16:19], s60 offen offset:0 lds
  s_waitcnt lgkmcnt(4)
  v_mfma_f32_16x16x32_bf16 v[12:15], v[72:75], a[176:179], v[12:15]
  buffer_load_dwordx4 v242, s[16:19], s60 offen offset:1024 lds
  v_and_b32 v252, 3, v0
  v_mfma_f32_16x16x32_bf16 v[16:19], v[72:75], a[180:183], v[16:19]
  ds_read_b64_tr_b16 v[68:69], v210 offset:57344
  v_lshl_add_u32 v253, v252, 3, v253
  v_mfma_f32_16x16x32_bf16 v[20:23], v[72:75], a[184:187], v[20:23]
  ds_read_b64_tr_b16 v[70:71], v210 offset:59392
  v_add_u32_e64 v231, 0, v253
  v_mfma_f32_16x16x32_bf16 v[24:27], v[72:75], a[188:191], v[24:27]
  v_add_u32 v230, 57344, v253
  v_add_u32_e64 v229, s51, v239
  v_mfma_f32_16x16x32_bf16 v[8:11], v[72:75], v[4:7], v[8:11]
  v_add_u32 v221, s51, v238
  s_waitcnt lgkmcnt(4)
  v_mfma_f32_16x16x32_bf16 v[12:15], v[60:63], a[192:195], v[12:15]
  buffer_load_dwordx4 v241, s[16:19], s60 offen offset:2048 lds
  v_mfma_f32_16x16x32_bf16 v[16:19], v[60:63], a[196:199], v[16:19]
  v_add_u32_e64 v220, s51, v237
  v_mfma_f32_16x16x32_bf16 v[20:23], v[60:63], a[200:203], v[20:23]
  ds_read_b64_tr_b16 v[72:73], v210 offset:61440
  v_mfma_f32_16x16x32_bf16 v[24:27], v[60:63], a[204:207], v[24:27]
  v_add_u32_e64 v219, s51, v236
  v_mfma_f32_16x16x32_bf16 v[8:11], v[60:63], v[4:7], v[8:11]
  ds_read_b64_tr_b16 v[74:75], v210 offset:63488
  s_waitcnt lgkmcnt(4)
  v_mfma_f32_16x16x32_bf16 v[12:15], v[64:67], a[208:211], v[12:15]
  buffer_load_dwordx4 v240, s[16:19], s60 offen offset:3072 lds
  v_mfma_f32_16x16x32_bf16 v[16:19], v[64:67], a[212:215], v[16:19]
  v_mfma_f32_16x16x32_bf16 v[20:23], v[64:67], a[216:219], v[20:23]
  v_mfma_f32_16x16x32_bf16 v[24:27], v[64:67], a[220:223], v[24:27]
  v_mfma_f32_16x16x32_bf16 v[8:11], v[64:67], v[4:7], v[8:11]
  s_waitcnt lgkmcnt(2)
  v_mfma_f32_16x16x32_bf16 v[12:15], v[68:71], a[224:227], v[12:15]
  s_add_u32 s59, s92, 2
  s_and_b32 s59, s59, 3
  v_mfma_f32_16x16x32_bf16 v[16:19], v[68:71], a[228:231], v[16:19]
  s_lshl2_add_u32 s59, s3, s59
  s_lshl_b32 s60, s59, 8
  v_mfma_f32_16x16x32_bf16 v[20:23], v[68:71], a[232:235], v[20:23]
  s_lshl_b32 s59, s59, 12
  s_add_u32 m0, s59, 98304
  v_mfma_f32_16x16x32_bf16 v[24:27], v[68:71], a[236:239], v[24:27]
  s_add_u32 s60, s60, s5
  s_lshl_b32 s60, s60, 7
  v_mfma_f32_16x16x32_bf16 v[8:11], v[68:71], v[4:7], v[8:11]
  buffer_load_dwordx4 v243, s[16:19], s60 offen offset:0 lds
  s_waitcnt lgkmcnt(0)
  v_mfma_f32_16x16x32_bf16 v[12:15], v[72:75], a[240:243], v[12:15]
  buffer_load_dwordx4 v242, s[16:19], s60 offen offset:1024 lds
  v_mfma_f32_16x16x32_bf16 v[16:19], v[72:75], a[244:247], v[16:19]
  v_mfma_f32_16x16x32_bf16 v[20:23], v[72:75], a[248:251], v[20:23]
  v_mfma_f32_16x16x32_bf16 v[24:27], v[72:75], a[252:255], v[24:27]
  v_mfma_f32_16x16x32_bf16 v[8:11], v[72:75], v[4:7], v[8:11]
  s_barrier
  s_nop 0
  s_nop 0
  s_nop 0
  s_nop 6
  v_pk_mul_f32 v[108:109], v[8:9], v[234:235] op_sel:[0,1] op_sel_hi:[1,1]
  buffer_load_dwordx4 v241, s[16:19], s60 offen offset:2048 lds
  s_nop 0
  v_pk_mul_f32 v[112:113], v[8:9], v[232:233] op_sel:[0,1] op_sel_hi:[1,1]
  v_pk_mul_f32 v[116:117], v[8:9], v[226:227] op_sel:[0,1] op_sel_hi:[1,1]
  v_pk_mul_f32 v[120:121], v[8:9], v[224:225] op_sel:[0,1] op_sel_hi:[1,1]
  v_pk_mul_f32 v[110:111], v[10:11], v[234:235] op_sel:[0,1] op_sel_hi:[1,1]
  v_pk_mul_f32 v[114:115], v[10:11], v[232:233] op_sel:[0,1] op_sel_hi:[1,1]
  v_pk_mul_f32 v[118:119], v[10:11], v[226:227] op_sel:[0,1] op_sel_hi:[1,1]
  v_pk_mul_f32 v[122:123], v[10:11], v[224:225] op_sel:[0,1] op_sel_hi:[1,1]
  v_pk_fma_f32 v[12:13], v[12:13], v[234:235], v[108:109] op_sel:[0,0,0] op_sel_hi:[1,0,1]
  v_pk_fma_f32 v[16:17], v[16:17], v[232:233], v[112:113] op_sel:[0,0,0] op_sel_hi:[1,0,1]
  v_pk_fma_f32 v[20:21], v[20:21], v[226:227], v[116:117] op_sel:[0,0,0] op_sel_hi:[1,0,1]
  v_pk_fma_f32 v[24:25], v[24:25], v[224:225], v[120:121] op_sel:[0,0,0] op_sel_hi:[1,0,1]
  v_pk_fma_f32 v[14:15], v[14:15], v[234:235], v[110:111] op_sel:[0,0,0] op_sel_hi:[1,0,1]
  v_pk_fma_f32 v[18:19], v[18:19], v[232:233], v[114:115] op_sel:[0,0,0] op_sel_hi:[1,0,1]
  v_pk_fma_f32 v[22:23], v[22:23], v[226:227], v[118:119] op_sel:[0,0,0] op_sel_hi:[1,0,1]
  v_pk_fma_f32 v[26:27], v[26:27], v[224:225], v[122:123] op_sel:[0,0,0] op_sel_hi:[1,0,1]
  v_cvt_pk_bf16_f32 v214, v12, v13
  v_cvt_pk_bf16_f32 v212, v16, v17
  v_cvt_pk_bf16_f32 v210, v20, v21
  v_cvt_pk_bf16_f32 v208, v24, v25
  v_cvt_pk_bf16_f32 v215, v14, v15
  v_cvt_pk_bf16_f32 v213, v18, v19
  v_cvt_pk_bf16_f32 v211, v22, v23
  v_cvt_pk_bf16_f32 v209, v26, v27
  v_mfma_f32_16x16x16_bf16 v[12:15], v[222:223], v[214:215], 0
  v_mfma_f32_16x16x16_bf16 v[16:19], v[222:223], v[212:213], 0
  buffer_load_dwordx4 v240, s[16:19], s60 offen offset:3072 lds
  v_mfma_f32_16x16x16_bf16 v[20:23], v[222:223], v[210:211], 0
  v_mfma_f32_16x16x16_bf16 v[24:27], v[222:223], v[208:209], 0
  s_nop 3
  v_max3_f32 v214, v12, v13, v14
  v_max3_f32 v212, v16, v17, v18
  s_nop 0
  v_max3_f32 v210, v20, v21, v22
  v_max3_f32 v208, v24, v25, v26
  v_max3_f32 v215, -v12, -v13, -v14
  v_max3_f32 v213, -v16, -v17, -v18
  v_max3_f32 v211, -v20, -v21, -v22
  v_max3_f32 v209, -v24, -v25, -v26
  v_max_f32 v214, v214, v15
  v_max_f32 v212, v212, v19
  v_max_f32 v210, v210, v23
  v_max_f32 v208, v208, v27
  v_max_f32_e64 v215, v215, -v15
  v_max_f32_e64 v213, v213, -v19
  v_max_f32_e64 v211, v211, -v23
  v_max_f32_e64 v209, v209, -v27
  s_add_u32 s59, s92, 3
  s_and_b32 s59, s59, 3
  s_lshl2_add_u32 s59, s3, s59
  s_lshl_b32 s60, s59, 8
  s_lshl_b32 s59, s59, 12
  s_add_u32 m0, s59, 98304
  s_add_u32 s60, s60, s5
  s_lshl_b32 s60, s60, 7
  buffer_load_dwordx4 v243, s[16:19], s60 offen offset:0 lds
  v_permlane32_swap_b32 v214, v215
  v_permlane32_swap_b32 v210, v211
  v_permlane32_swap_b32 v212, v213
  v_permlane32_swap_b32 v208, v209
  v_max_f32 v214, v214, v215
  v_max_f32 v210, v210, v211
  v_max_f32 v212, v212, v213
  v_max_f32 v208, v208, v209
  s_nop 0
  v_permlane16_swap_b32 v214, v212
  v_permlane16_swap_b32 v210, v208
  v_max_f32 v214, v214, v212
  v_max_f32 v210, v210, v208
  v_mul_f32 v214, s69, v214
  v_mul_f32 v210, s69, v210
  v_mov_b32 v212, v214
  v_mov_b32 v208, v210
  s_nop 0
  v_permlane16_swap_b32 v214, v212
  v_permlane16_swap_b32 v210, v208
  v_mov_b32 v215, v214
  v_mov_b32_e64 v211, v210
  buffer_load_dwordx4 v242, s[16:19], s60 offen offset:1024 lds
  v_mov_b32 v213, v212
  v_mov_b32 v209, v208
  v_permlane32_swap_b32 v214, v215
  v_permlane32_swap_b32 v210, v211
  v_permlane32_swap_b32 v212, v213
  v_permlane32_swap_b32 v208, v209
  s_cmp_lg_u32 s3, 0
  s_cbranch_scc1 L_g1_2
  buffer_load_dwordx4 v[28:31], v246, s[28:31], s6 offen offset:0 sc1
  buffer_load_dwordx4 v[32:35], v246, s[28:31], s6 offen offset:1024 sc1
  buffer_load_dwordx4 v[36:39], v246, s[28:31], s6 offen offset:2048 sc1
  buffer_load_dwordx4 v[40:43], v246, s[28:31], s6 offen offset:3072 sc1
  buffer_load_dwordx4 v[44:47], v246, s[28:31], s41 offen offset:0 sc1
  buffer_load_dwordx4 v[48:51], v246, s[28:31], s41 offen offset:1024 sc1
  buffer_load_dwordx4 v[52:55], v246, s[28:31], s41 offen offset:2048 sc1
  buffer_load_dwordx4 v[56:59], v246, s[28:31], s41 offen offset:3072 sc1
L_g1_2:
  v_pk_fma_f32 v[108:109], v[12:13], s[68:69], v[214:215] op_sel:[0,1,1] op_sel_hi:[1,1,1]
  v_pk_fma_f32 v[112:113], v[16:17], s[68:69], v[212:213] op_sel:[0,1,1] op_sel_hi:[1,1,1]
  v_pk_fma_f32 v[116:117], v[20:21], s[68:69], v[210:211] op_sel:[0,1,1] op_sel_hi:[1,1,1]
  v_pk_fma_f32 v[120:121], v[24:25], s[68:69], v[208:209] op_sel:[0,1,1] op_sel_hi:[1,1,1]
  v_pk_fma_f32 v[12:13], v[12:13], s[68:69], v[214:215] op_sel:[0,0,0] op_sel_hi:[1,0,0]
  v_pk_fma_f32 v[16:17], v[16:17], s[68:69], v[212:213] op_sel:[0,0,0] op_sel_hi:[1,0,0]
  v_pk_fma_f32 v[20:21], v[20:21], s[68:69], v[210:211] op_sel:[0,0,0] op_sel_hi:[1,0,0]
  v_pk_fma_f32 v[24:25], v[24:25], s[68:69], v[208:209] op_sel:[0,0,0] op_sel_hi:[1,0,0]
  v_pk_fma_f32 v[110:111], v[14:15], s[68:69], v[214:215] op_sel:[0,1,1] op_sel_hi:[1,1,1]
  v_pk_fma_f32 v[114:115], v[18:19], s[68:69], v[212:213] op_sel:[0,1,1] op_sel_hi:[1,1,1]
  v_pk_fma_f32 v[118:119], v[22:23], s[68:69], v[210:211] op_sel:[0,1,1] op_sel_hi:[1,1,1]
  v_pk_fma_f32 v[122:123], v[26:27], s[68:69], v[208:209] op_sel:[0,1,1] op_sel_hi:[1,1,1]
  v_pk_fma_f32 v[14:15], v[14:15], s[68:69], v[214:215] op_sel:[0,0,0] op_sel_hi:[1,0,0]
  v_pk_fma_f32 v[18:19], v[18:19], s[68:69], v[212:213] op_sel:[0,0,0] op_sel_hi:[1,0,0]
  v_pk_fma_f32 v[22:23], v[22:23], s[68:69], v[210:211] op_sel:[0,0,0] op_sel_hi:[1,0,0]
  v_pk_fma_f32 v[26:27], v[26:27], s[68:69], v[208:209] op_sel:[0,0,0] op_sel_hi:[1,0,0]
  v_exp_f32_e64 v12, v12
  buffer_load_dwordx4 v241, s[16:19], s60 offen offset:2048 lds
  v_exp_f32 v16, v16
  v_exp_f32 v20, v20
  v_exp_f32 v24, v24
  v_exp_f32 v108, v108
  v_exp_f32 v112, v112
  v_exp_f32 v116, v116
  v_exp_f32 v120, v120
  v_exp_f32 v13, v13
  v_exp_f32 v17, v17
  v_exp_f32 v21, v21
  v_exp_f32 v25, v25
  v_exp_f32 v109, v109
  v_exp_f32 v113, v113
  v_exp_f32 v117, v117
  buffer_load_dwordx4 v240, s[16:19], s60 offen offset:3072 lds
  v_exp_f32 v121, v121
  v_exp_f32 v14, v14
  v_exp_f32 v18, v18
  v_exp_f32 v22, v22
  v_exp_f32 v26, v26
  v_exp_f32 v110, v110
  v_exp_f32 v114, v114
  v_exp_f32 v118, v118
  v_exp_f32 v122, v122
  v_exp_f32 v15, v15
  v_exp_f32 v19, v19
  v_exp_f32 v23, v23
  v_exp_f32 v27, v27
  s_add_u32 m0, s13, 0
  s_add_u32 s12, s92, 0
  s_and_b32 s12, s12, 3
  s_mul_i32 s12, s12, 458752
  s_add_u32 s12, s12, s14
  s_mov_b32 exec_hi, 0xffffff
  buffer_load_dwordx4 v199, s[20:23], s12 offen lds
  s_mov_b32 exec_hi, -1
  v_exp_f32 v111, v111
  v_exp_f32 v115, v115
  v_exp_f32 v119, v119
  v_exp_f32 v123, v123
  v_pk_add_f32 v[124:125], v[12:13], v[14:15]
  v_pk_add_f32 v[128:129], v[16:17], v[18:19]
  v_pk_add_f32 v[132:133], v[20:21], v[22:23]
  v_pk_add_f32 v[136:137], v[24:25], v[26:27]
  v_pk_add_f32 v[126:127], v[108:109], v[110:111]
  v_pk_add_f32 v[130:131], v[112:113], v[114:115]
  v_pk_add_f32 v[134:135], v[116:117], v[118:119]
  v_pk_add_f32 v[138:139], v[120:121], v[122:123]
  v_add_f32 v214, v124, v125
  v_add_f32 v212, v128, v129
  v_add_f32 v210, v132, v133
  v_add_f32 v208, v136, v137
  v_add_f32 v215, v126, v127
  v_add_f32 v213, v130, v131
  v_add_f32 v211, v134, v135
  v_add_f32 v209, v138, v139
  v_permlane32_swap_b32 v214, v215
  v_permlane32_swap_b32 v210, v211
  s_add_u32 m0, s13, 896
  s_add_u32 s12, s12, 14336
  s_mov_b32 exec_hi, 0xffffff
  buffer_load_dwordx4 v199, s[20:23], s12 offen lds
  s_mov_b32 exec_hi, -1
  v_permlane32_swap_b32 v212, v213
  v_permlane32_swap_b32 v208, v209
  v_add_f32 v214, v214, v215
  v_add_f32 v210, v210, v211
  v_add_f32 v212, v212, v213
  v_add_f32 v208, v208, v209
  s_nop 0
  v_permlane16_swap_b32 v214, v212
  v_permlane16_swap_b32 v210, v208
  v_add_f32 v214, v214, v212
  v_add_f32 v210, v210, v208
  v_rcp_f32 v214, v214
  v_rcp_f32 v210, v210
  v_mov_b32 v212, v214
  v_mov_b32 v208, v210
  s_nop 0
  v_permlane16_swap_b32 v214, v212
  v_permlane16_swap_b32 v210, v208
  v_mov_b32 v215, v214
  v_mov_b32 v211, v210
  v_mov_b32 v213, v212
  s_add_u32 m0, s13, 1792
  s_add_u32 s12, s12, 14336
  s_mov_b32 exec_hi, 0xffffff
  buffer_load_dwordx4 v199, s[20:23], s12 offen lds
  s_mov_b32 exec_hi, -1
  v_mov_b32 v209, v208
  v_permlane32_swap_b32 v214, v215
  v_permlane32_swap_b32 v210, v211
  v_permlane32_swap_b32 v212, v213
  v_permlane32_swap_b32 v208, v209
  s_nop 0
  s_nop 0
  v_pk_mul_f32 v[12:13], v[12:13], v[214:215] op_sel:[0,0] op_sel_hi:[1,0]
  v_pk_mul_f32 v[16:17], v[16:17], v[212:213] op_sel:[0,0] op_sel_hi:[1,0]
  v_pk_mul_f32 v[20:21], v[20:21], v[210:211] op_sel:[0,0] op_sel_hi:[1,0]
  v_pk_mul_f32 v[24:25], v[24:25], v[208:209] op_sel:[0,0] op_sel_hi:[1,0]
  v_pk_mul_f32 v[14:15], v[14:15], v[214:215] op_sel:[0,0] op_sel_hi:[1,0]
  v_pk_mul_f32 v[18:19], v[18:19], v[212:213] op_sel:[0,0] op_sel_hi:[1,0]
  v_pk_mul_f32 v[22:23], v[22:23], v[210:211] op_sel:[0,0] op_sel_hi:[1,0]
  v_pk_mul_f32 v[26:27], v[26:27], v[208:209] op_sel:[0,0] op_sel_hi:[1,0]
  v_pk_mul_f32 v[108:109], v[108:109], v[214:215] op_sel:[0,1] op_sel_hi:[1,1]
  v_pk_mul_f32 v[112:113], v[112:113], v[212:213] op_sel:[0,1] op_sel_hi:[1,1]
  v_pk_mul_f32 v[116:117], v[116:117], v[210:211] op_sel:[0,1] op_sel_hi:[1,1]
  v_pk_mul_f32 v[120:121], v[120:121], v[208:209] op_sel:[0,1] op_sel_hi:[1,1]
  v_pk_mul_f32 v[110:111], v[110:111], v[214:215] op_sel:[0,1] op_sel_hi:[1,1]
  v_pk_mul_f32 v[114:115], v[114:115], v[212:213] op_sel:[0,1] op_sel_hi:[1,1]
  v_pk_mul_f32 v[118:119], v[118:119], v[210:211] op_sel:[0,1] op_sel_hi:[1,1]
  v_pk_mul_f32 v[122:123], v[122:123], v[208:209] op_sel:[0,1] op_sel_hi:[1,1]
  v_cvt_pk_bf16_f32 v76, v12, v13
  v_cvt_pk_bf16_f32 v80, v16, v17
  v_cvt_pk_bf16_f32 v84, v20, v21
  s_add_u32 m0, s13, 2688
  s_add_u32 s12, s12, 14336
  s_mov_b32 exec_hi, 0xffffff
  buffer_load_dwordx4 v199, s[20:23], s12 offen lds
  s_mov_b32 exec_hi, -1
  s_nop 0
  v_cvt_pk_bf16_f32 v104, v24, v25
  v_cvt_pk_bf16_f32 v77, v14, v15
  v_cvt_pk_bf16_f32 v81, v18, v19
  v_cvt_pk_bf16_f32 v85, v22, v23
  v_cvt_pk_bf16_f32 v105, v26, v27
  v_cvt_pk_bf16_f32 v78, v108, v109
  v_cvt_pk_bf16_f32 v82, v112, v113
  v_cvt_pk_bf16_f32 v86, v116, v117
  v_cvt_pk_bf16_f32 v106, v120, v121
  v_cvt_pk_bf16_f32 v79, v110, v111
  v_cvt_pk_bf16_f32 v83, v114, v115
  v_cvt_pk_bf16_f32 v87, v118, v119
  v_cvt_pk_bf16_f32 v107, v122, v123
  s_add_u32 m0, s13, 3584
  s_add_u32 s12, s12, 14336
  s_mov_b32 exec_hi, 0xffffff
  buffer_load_dwordx4 v199, s[20:23], s12 offen lds
  s_mov_b32 exec_hi, -1
  s_add_u32 m0, s13, 4480
  s_add_u32 s12, s12, 14336
  s_mov_b32 exec_hi, 0xffffff
  buffer_load_dwordx4 v199, s[20:23], s12 offen lds
  s_mov_b32 exec_hi, -1
  s_add_u32 m0, s13, 5376
  s_add_u32 s12, s12, 14336
  s_mov_b32 exec_hi, 0xffffff
  buffer_load_dwordx4 v199, s[20:23], s12 offen lds
  s_mov_b32 exec_hi, -1
  s_add_u32 m0, s13, 6272
  s_add_u32 s12, s12, 14336
  s_mov_b32 exec_hi, 0xffffff
  buffer_load_dwordx4 v199, s[20:23], s12 offen lds
  s_mov_b32 exec_hi, -1
  s_add_u32 m0, s13, 28672
  s_add_u32 s12, s92, 1
  s_and_b32 s12, s12, 3
  s_mul_i32 s12, s12, 458752
  s_add_u32 s12, s12, s14
  s_mov_b32 exec_hi, 0xffffff
  buffer_load_dwordx4 v199, s[20:23], s12 offen lds
  s_mov_b32 exec_hi, -1
  s_add_u32 m0, s13, 29568
  s_add_u32 s12, s12, 14336
  s_mov_b32 exec_hi, 0xffffff
  buffer_load_dwordx4 v199, s[20:23], s12 offen lds
  s_mov_b32 exec_hi, -1
  s_waitcnt vmcnt(10)
  s_barrier
  s_cmp_eq_u32 s40, 0
  s_cbranch_scc1 L_own_3
L_own_back_4:
  ds_read_b64 v[96:97], v198
  s_add_u32 m0, s13, 30464
  s_add_u32 s12, s12, 14336
  s_mov_b32 exec_hi, 0xffffff
  buffer_load_dwordx4 v199, s[20:23], s12 offen lds
  s_mov_b32 exec_hi, -1
  ds_read_b64 v[98:99], v197
  ds_read_b64 v[100:101], v196
  ds_read_b64 v[102:103], v195
  ds_read_b64_tr_b16 a[0:1], v239 offset:0
  ds_read_b64_tr_b16 a[2:3], v239 offset:2048
  ds_read_b64_tr_b16 a[4:5], v238 offset:0
  ds_read_b64_tr_b16 a[6:7], v238 offset:2048
  ds_read_b64_tr_b16 a[8:9], v237 offset:0
  ds_read_b64_tr_b16 a[10:11], v237 offset:2048
  ds_read_b64_tr_b16 a[12:13], v236 offset:0
  ds_read_b64_tr_b16 a[14:15], v236 offset:2048
  ds_read_b64_tr_b16 a[16:17], v239 offset:4096
  ds_read_b64_tr_b16 a[18:19], v239 offset:6144
  ds_read_b64_tr_b16 a[20:21], v238 offset:4096
  s_add_u32 m0, s13, 31360
  s_add_u32 s12, s12, 14336
  s_mov_b32 exec_hi, 0xffffff
  buffer_load_dwordx4 v199, s[20:23], s12 offen lds
  s_mov_b32 exec_hi, -1
  ds_read_b64_tr_b16 a[22:23], v238 offset:6144
  ds_read_b64_tr_b16 a[24:25], v237 offset:4096
  ds_read_b64_tr_b16 a[26:27], v237 offset:6144
  ds_read_b64_tr_b16 a[28:29], v236 offset:4096
  ds_read_b64_tr_b16 a[30:31], v236 offset:6144
  ds_read_b64_tr_b16 a[32:33], v239 offset:8192
  ds_read_b64_tr_b16 a[34:35], v239 offset:10240
  ds_read_b64_tr_b16 a[36:37], v238 offset:8192
  ds_read_b64_tr_b16 a[38:39], v238 offset:10240
  ds_read_b64_tr_b16 a[40:41], v237 offset:8192
  ds_read_b64_tr_b16 a[42:43], v237 offset:10240
  ds_read_b64_tr_b16 a[44:45], v236 offset:8192
  ds_read_b64_tr_b16 a[46:47], v236 offset:10240
  ds_read_b64_tr_b16 a[48:49], v239 offset:12288
  s_add_u32 m0, s13, 32256
  s_add_u32 s12, s12, 14336
  s_mov_b32 exec_hi, 0xffffff
  buffer_load_dwordx4 v199, s[20:23], s12 offen lds
  s_mov_b32 exec_hi, -1
  ds_read_b64_tr_b16 a[50:51], v239 offset:14336
  ds_read_b64_tr_b16 a[52:53], v238 offset:12288
  ds_read_b64_tr_b16 a[54:55], v238 offset:14336
  ds_read_b64_tr_b16 a[56:57], v237 offset:12288
  ds_read_b64_tr_b16 a[58:59], v237 offset:14336
  ds_read_b64_tr_b16 a[60:61], v236 offset:12288
  ds_read_b64_tr_b16 a[62:63], v236 offset:14336
  ds_read_b64_tr_b16 a[64:65], v239 offset:16384
  ds_read_b64_tr_b16 a[66:67], v239 offset:18432
  ds_read_b64_tr_b16 a[68:69], v238 offset:16384
  ds_read_b64_tr_b16 a[70:71], v238 offset:18432
  ds_read_b64_tr_b16 a[72:73], v237 offset:16384
  ds_read_b64_tr_b16 a[74:75], v237 offset:18432
  ds_read_b64_tr_b16 a[76:77], v236 offset:16384
  s_add_u32 m0, s13, 33152
  s_add_u32 s12, s12, 14336
  s_mov_b32 exec_hi, 0xffffff
  buffer_load_dwordx4 v199, s[20:23], s12 offen lds
  s_mov_b32 exec_hi, -1
  ds_read_b64_tr_b16 a[78:79], v236 offset:18432
  ds_read_b64_tr_b16 a[80:81], v239 offset:20480
  ds_read_b64_tr_b16 a[82:83], v239 offset:22528
  ds_read_b64_tr_b16 a[84:85], v238 offset:20480
  ds_read_b64_tr_b16 a[86:87], v238 offset:22528
  ds_read_b64_tr_b16 a[88:89], v237 offset:20480
  ds_read_b64_tr_b16 a[90:91], v237 offset:22528
  ds_read_b64_tr_b16 a[92:93], v236 offset:20480
  ds_read_b64_tr_b16 a[94:95], v236 offset:22528
  ds_read_b64_tr_b16 a[96:97], v239 offset:24576
  ds_read_b64_tr_b16 a[98:99], v239 offset:26624
  ds_read_b64_tr_b16 a[100:101], v238 offset:24576
  ds_read_b64_tr_b16 a[102:103], v238 offset:26624
  ds_read_b64_tr_b16 a[104:105], v237 offset:24576
  s_add_u32 m0, s13, 34048
  s_add_u32 s12, s12, 14336
  s_mov_b32 exec_hi, 0xffffff
  buffer_load_dwordx4 v199, s[20:23], s12 offen lds
  s_mov_b32 exec_hi, -1
  ds_read_b64_tr_b16 a[106:107], v237 offset:26624
  ds_read_b64_tr_b16 a[108:109], v236 offset:24576
  ds_read_b64_tr_b16 a[110:111], v236 offset:26624
  ds_read_b64_tr_b16 a[112:113], v239 offset:28672
  ds_read_b64_tr_b16 a[114:115], v239 offset:30720
  ds_read_b64_tr_b16 a[116:117], v238 offset:28672
  ds_read_b64_tr_b16 a[118:119], v238 offset:30720
  ds_read_b64_tr_b16 a[120:121], v237 offset:28672
  ds_read_b64_tr_b16 a[122:123], v237 offset:30720
  ds_read_b64_tr_b16 a[124:125], v236 offset:28672
  ds_read_b64_tr_b16 a[126:127], v236 offset:30720
  ds_read_b64_tr_b16 a[128:129], v239 offset:32768
  ds_read_b64_tr_b16 a[130:131], v239 offset:34816
  ds_read_b64_tr_b16 a[132:133], v238 offset:32768
  s_add_u32 m0, s13, 34944
  s_add_u32 s12, s12, 14336
  s_mov_b32 exec_hi, 0xffffff
  buffer_load_dwordx4 v199, s[20:23], s12 offen lds
  s_mov_b32 exec_hi, -1
  ds_read_b64_tr_b16 a[134:135], v238 offset:34816
  ds_read_b64_tr_b16 a[136:137], v237 offset:32768
  ds_read_b64_tr_b16 a[138:139], v237 offset:34816
  ds_read_b64_tr_b16 a[140:141], v236 offset:32768
  ds_read_b64_tr_b16 a[142:143], v236 offset:34816
  ds_read_b64_tr_b16 a[144:145], v239 offset:36864
  ds_read_b64_tr_b16 a[146:147], v239 offset:38912
  ds_read_b64_tr_b16 a[148:149], v238 offset:36864
  ds_read_b64_tr_b16 a[150:151], v238 offset:38912
  ds_read_b64_tr_b16 a[152:153], v237 offset:36864
  ds_read_b64_tr_b16 a[154:155], v237 offset:38912
  ds_read_b64_tr_b16 a[156:157], v236 offset:36864
  ds_read_b64_tr_b16 a[158:159], v236 offset:38912
  v_lshlrev_b32 v92, 16, v190
  v_and_b32 v93, 0xffff0000, v190
  v_lshlrev_b32_e64 v94, 16, v191
  v_and_b32 v95, 0xffff0000, v191
  s_waitcnt lgkmcnt(0)
  s_barrier
  v_mul_u32_u24 v251, 1024, v0
  s_lshr_b32 s58, s2, 3
  s_lshl2_add_u32 s58, s58, s3
  s_mul_i32 s58, s58, 14336
  s_sub_u32 s59, 384, s24
  s_and_b32 s59, s59, 896
  s_add_u32 s58, s58, s59
  s_mov_b64 exec, 0x3fff
  buffer_load_dword v250, v251, s[24:27], s58 offen offset:0
  s_mov_b64 exec, -1
  s_cmp_eq_u32 s40, 0
  s_cbranch_scc1 L_own_9
L_own_back_10:
  s_add_u32 m0, s13, 57344
  s_add_u32 s12, s92, 2
  s_and_b32 s12, s12, 3
  s_mul_i32 s12, s12, 458752
  s_add_u32 s12, s12, s14
  s_mov_b32 exec_hi, 0xffffff
  buffer_load_dwordx4 v199, s[20:23], s12 offen lds
  s_mov_b32 exec_hi, -1
  s_add_u32 m0, s13, 58240
  s_add_u32 s12, s12, 14336
  s_mov_b32 exec_hi, 0xffffff
  buffer_load_dwordx4 v199, s[20:23], s12 offen lds
  s_mov_b32 exec_hi, -1
  s_add_u32 m0, s13, 59136
  s_add_u32 s12, s12, 14336
  s_mov_b32 exec_hi, 0xffffff
  buffer_load_dwordx4 v199, s[20:23], s12 offen lds
  s_mov_b32 exec_hi, -1
  s_add_u32 m0, s13, 60032
  s_add_u32 s12, s12, 14336
  s_mov_b32 exec_hi, 0xffffff
  buffer_load_dwordx4 v199, s[20:23], s12 offen lds
  s_mov_b32 exec_hi, -1
  s_add_u32 m0, s13, 60928
  s_add_u32 s12, s12, 14336
  s_mov_b32 exec_hi, 0xffffff
  buffer_load_dwordx4 v199, s[20:23], s12 offen lds
  s_mov_b32 exec_hi, -1
  s_add_u32 m0, s13, 61824
  s_add_u32 s12, s12, 14336
  s_mov_b32 exec_hi, 0xffffff
  buffer_load_dwordx4 v199, s[20:23], s12 offen lds
  s_mov_b32 exec_hi, -1
  s_waitcnt vmcnt(6)
  s_cmp_eq_u32 s40, 0
  s_cbranch_scc1 L_own_13
L_own_back_14:
  buffer_load_dwordx4 v[68:71], v246, s[28:31], s87 offen offset:0 sc1
  buffer_load_dwordx4 v[72:75], v246, s[28:31], s87 offen offset:1024 sc1
  buffer_load_dwordx2 v[216:217], v244, s[28:31], s90 offen sc1
  s_add_u32 m0, s13, 62720
  s_add_u32 s12, s12, 14336
  s_mov_b32 exec_hi, 0xffffff
  buffer_load_dwordx4 v199, s[20:23], s12 offen lds
  s_mov_b32 exec_hi, -1
  s_add_u32 m0, s13, 63616
  s_add_u32 s12, s12, 14336
  s_mov_b32 exec_hi, 0xffffff
  buffer_load_dwordx4 v199, s[20:23], s12 offen lds
  s_mov_b32 exec_hi, -1
  s_add_u32 m0, s13, 86016
  s_add_u32 s12, s92, 3
  s_and_b32 s12, s12, 3
  s_mul_i32 s12, s12, 458752
  s_add_u32 s12, s12, s14
  s_mov_b32 exec_hi, 0xffffff
  buffer_load_dwordx4 v199, s[20:23], s12 offen lds
  s_mov_b32 exec_hi, -1
  s_add_u32 m0, s13, 86912
  s_add_u32 s12, s12, 14336
  s_mov_b32 exec_hi, 0xffffff
  buffer_load_dwordx4 v199, s[20:23], s12 offen lds
  s_mov_b32 exec_hi, -1
  s_add_u32 m0, s13, 87808
  s_add_u32 s12, s12, 14336
  s_mov_b32 exec_hi, 0xffffff
  buffer_load_dwordx4 v199, s[20:23], s12 offen lds
  s_mov_b32 exec_hi, -1
  s_add_u32 m0, s13, 88704
  s_add_u32 s12, s12, 14336
  s_mov_b32 exec_hi, 0xffffff
  buffer_load_dwordx4 v199, s[20:23], s12 offen lds
  s_mov_b32 exec_hi, -1
  s_waitcnt vmcnt(6)
  s_mov_b32 s8, 2
  v_xor_b32 v255, v71, v245
  v_xor_b32 v254, v75, v245
  v_xor_b32 v253, v217, v245
  v_or3_b32 v255, v255, v254, v253
  v_cmp_ne_u32 vcc, 0, v255
  s_cbranch_vccz L_g2_go_8
  s_mov_b32 s8, 2
  s_mov_b32 s57, 0
  s_cmp_eq_u32 s40, 0
  s_cbranch_scc1 L_own_17
L_own_back_18:
L_g2_chk_7:
  buffer_load_dwordx4 v[68:71], v246, s[28:31], s87 offen offset:0 sc1
  buffer_load_dwordx4 v[72:75], v246, s[28:31], s87 offen offset:1024 sc1
  buffer_load_dwordx2 v[216:217], v244, s[28:31], s90 offen sc1
  s_waitcnt vmcnt(0)
  v_xor_b32 v255, v71, v245
  v_xor_b32 v254, v75, v245
  v_xor_b32 v253, v217, v245
  v_or3_b32 v255, v255, v254, v253
  v_cmp_ne_u32_e64 vcc, 0, v255
  s_cbranch_vccz L_g2_go_8
  s_add_u32 s57, s57, 1
  s_cmp_le_u32 s57, 262144
  s_cbranch_scc1 L_g2_chk_7
L_g2_go_8:
  s_cmp_eq_u32 s40, 0
  s_cbranch_scc1 L_own_21
L_own_back_22:
  v_cmp_ne_u32 vcc, s48, v216
  v_mov_b32_dpp v8, v70 quad_perm:[0,0,0,0] row_mask:0xf bank_mask:0xf
  v_mov_b32_dpp v9, v70 quad_perm:[1,1,1,1] row_mask:0xf bank_mask:0xf
  v_mov_b32_dpp v10, v74 quad_perm:[0,0,0,0] row_mask:0xf bank_mask:0xf
  v_mov_b32_dpp v11, v74 quad_perm:[1,1,1,1] row_mask:0xf bank_mask:0xf
  v_mov_b32 v70, v72
  v_mov_b32 v71, v73
  s_cmp_eq_u64 vcc, 0
  s_cselect_b32 s48, 1, 0
  v_mfma_f32_16x16x32_bf16 v[32:35], v[8:11], v[76:79], 0
  v_mfma_f32_16x16x32_bf16 v[36:39], v[8:11], v[80:83], 0
  v_mfma_f32_16x16x32_bf16 v[40:43], v[8:11], v[84:87], 0
  v_mfma_f32_16x16x32_bf16 v[44:47], v[8:11], v[104:107], 0
  v_mfma_f32_16x16x32_bf16 v[12:15], v[68:71], v[76:79], 0
  v_mfma_f32_16x16x32_bf16 v[16:19], v[68:71], v[80:83], 0
  v_mfma_f32_16x16x32_bf16 v[20:23], v[68:71], v[84:87], 0
  v_mfma_f32_16x16x32_bf16 v[24:27], v[68:71], v[104:107], 0
  s_nop 0
  v_add_f32 v32, 897988541, v32
  v_add_f32 v36, 897988541, v36
  v_add_f32 v40, 897988541, v40
  v_add_f32 v44, 897988541, v44
  v_rcp_f32 v32, v32
  v_rcp_f32 v36, v36
  v_rcp_f32 v40, v40
  v_rcp_f32_e64 v44, v44
  v_pk_mul_f32 v[12:13], v[12:13], v[32:33] op_sel:[0,0] op_sel_hi:[1,0]
  v_pk_mul_f32 v[16:17], v[16:17], v[36:37] op_sel:[0,0] op_sel_hi:[1,0]
  v_pk_mul_f32 v[20:21], v[20:21], v[40:41] op_sel:[0,0] op_sel_hi:[1,0]
  v_pk_mul_f32 v[24:25], v[24:25], v[44:45] op_sel:[0,0] op_sel_hi:[1,0]
  v_pk_mul_f32 v[14:15], v[14:15], v[32:33] op_sel:[0,0] op_sel_hi:[1,0]
  v_pk_mul_f32 v[18:19], v[18:19], v[36:37] op_sel:[0,0] op_sel_hi:[1,0]
  v_pk_mul_f32 v[22:23], v[22:23], v[40:41] op_sel:[0,0] op_sel_hi:[1,0]
  v_pk_mul_f32 v[26:27], v[26:27], v[44:45] op_sel:[0,0] op_sel_hi:[1,0]
  v_cvt_pk_bf16_f32 v34, v12, v13
  v_cvt_pk_bf16_f32 v38, v16, v17
  v_cvt_pk_bf16_f32 v42, v20, v21
  v_cvt_pk_bf16_f32 v46, v24, v25
  v_cvt_pk_bf16_f32 v35, v14, v15
  v_cvt_pk_bf16_f32 v39, v18, v19
  v_cvt_pk_bf16_f32 v43, v22, v23
  v_cvt_pk_bf16_f32 v47, v26, v27
  s_barrier
  s_cmp_eq_u32 s48, 0
  s_cbranch_scc1 L_st_slow_25
  buffer_store_dwordx2 v[34:35], v246, s[28:31], s65 offen
  buffer_store_dwordx2 v[38:39], v246, s[28:31], s66 offen
  buffer_store_dwordx2 v[42:43], v246, s[28:31], s67 offen
  buffer_store_dwordx2 v[46:47], v246, s[28:31], s72 offen
L_st_done_26:
  s_cmp_lt_u32 s8, 2
  s_cbranch_scc1 L_left_27
L_left_back_28:
  ds_read_b64_tr_b16 a[160:161], v239 offset:40960
  s_add_u32 m0, s13, 89600
  s_add_u32 s12, s12, 14336
  s_mov_b32 exec_hi, 0xffffff
  buffer_load_dwordx4 v199, s[20:23], s12 offen lds
  s_mov_b32 exec_hi, -1
  ds_read_b64_tr_b16 a[162:163], v239 offset:43008
  ds_read_b64_tr_b16 a[164:165], v238 offset:40960
  ds_read_b64_tr_b16 a[166:167], v238 offset:43008
  ds_read_b64_tr_b16 a[168:169], v237 offset:40960
  ds_read_b64_tr_b16 a[170:171], v237 offset:43008
  ds_read_b64_tr_b16 a[172:173], v236 offset:40960
  ds_read_b64_tr_b16 a[174:175], v236 offset:43008
  ds_read_b64_tr_b16 a[176:177], v239 offset:45056
  ds_read_b64_tr_b16 a[178:179], v239 offset:47104
  ds_read_b64_tr_b16 a[180:181], v238 offset:45056
  s_add_u32 m0, s13, 90496
  s_add_u32 s12, s12, 14336
  s_mov_b32 exec_hi, 0xffffff
  buffer_load_dwordx4 v199, s[20:23], s12 offen lds
  s_mov_b32 exec_hi, -1
  ds_read_b64_tr_b16 a[182:183], v238 offset:47104
  ds_read_b64_tr_b16 a[184:185], v237 offset:45056
  ds_read_b64_tr_b16 a[186:187], v237 offset:47104
  ds_read_b64_tr_b16 a[188:189], v236 offset:45056
  ds_read_b64_tr_b16 a[190:191], v236 offset:47104
  ds_read_b64_tr_b16 a[192:193], v239 offset:49152
  ds_read_b64_tr_b16 a[194:195], v239 offset:51200
  ds_read_b64_tr_b16 a[196:197], v238 offset:49152
  ds_read_b64_tr_b16 a[198:199], v238 offset:51200
  ds_read_b64_tr_b16 a[200:201], v237 offset:49152
  s_add_u32 m0, s13, 91392
  s_add_u32 s12, s12, 14336
  s_mov_b32 exec_hi, 0xffffff
  buffer_load_dwordx4 v199, s[20:23], s12 offen lds
  s_mov_b32 exec_hi, -1
  ds_read_b64_tr_b16 a[202:203], v237 offset:51200
  ds_read_b64_tr_b16 a[204:205], v236 offset:49152
  ds_read_b64_tr_b16 a[206:207], v236 offset:51200
  ds_read_b64_tr_b16 a[208:209], v239 offset:53248
  ds_read_b64_tr_b16 a[210:211], v239 offset:55296
  ds_read_b64_tr_b16 a[212:213], v238 offset:53248
  ds_read_b64_tr_b16 a[214:215], v238 offset:55296
  ds_read_b64_tr_b16 a[216:217], v237 offset:53248
  ds_read_b64_tr_b16 a[218:219], v237 offset:55296
  ds_read_b64_tr_b16 a[220:221], v236 offset:53248
  s_add_u32 m0, s13, 92288
  s_add_u32 s12, s12, 14336
  s_mov_b32 exec_hi, 0xffffff
  buffer_load_dwordx4 v199, s[20:23], s12 offen lds
  s_mov_b32 exec_hi, -1
  ds_read_b64_tr_b16 a[222:223], v236 offset:55296
  ds_read_b64_tr_b16 a[224:225], v239 offset:57344
  ds_read_b64_tr_b16 a[226:227], v239 offset:59392
  ds_read_b64_tr_b16 a[228:229], v238 offset:57344
  ds_read_b64_tr_b16 a[230:231], v238 offset:59392
  ds_read_b64_tr_b16 a[232:233], v237 offset:57344
  ds_read_b64_tr_b16 a[234:235], v237 offset:59392
  ds_read_b64_tr_b16 a[236:237], v236 offset:57344
  ds_read_b64_tr_b16 a[238:239], v236 offset:59392
  ds_read_b64_tr_b16 a[240:241], v239 offset:61440
  ds_read_b64_tr_b16 a[242:243], v239 offset:63488
  ds_read_b64_tr_b16 a[244:245], v238 offset:61440
  ds_read_b64_tr_b16 a[246:247], v238 offset:63488
  ds_read_b64_tr_b16 a[248:249], v237 offset:61440
  ds_read_b64_tr_b16 a[250:251], v237 offset:63488
  ds_read_b64_tr_b16 a[252:253], v236 offset:61440
  ds_read_b64_tr_b16 a[254:255], v236 offset:63488
  s_waitcnt vmcnt(4) lgkmcnt(0)
  s_barrier
  s_cmp_lg_u32 s3, 0
  s_cbranch_scc1 L_fl_skip_29
  s_mov_b64 exec, 1
  s_cmp_eq_u32 s48, 0
  s_cbranch_scc1 L_fl_slow_30
  buffer_store_dword v245, v244, s[28:31], s36 offen offset:8
L_fl_skip_29:
  s_mov_b64 exec, -1
  s_and_b32 s56, s36, 4294966272
  s_mov_b64 exec, 255
  s_mov_b32 s57, 0
  buffer_load_dword v2, v244, s[28:31], s56 offen offset:8 sc1
  s_mov_b64 exec, -1
  s_add_u32 s38, s38, s42
  s_add_u32 s39, s39, s42
  s_lshl_b32 s51, s3, 5
  s_add_u32 s52, s3, 4
  s_min_u32 s52, s52, 6
  s_lshl_b32 s52, s52, 5
  v_add_u32 v239, s51, v231
  v_add_u32 v238, s51, v230
  v_add_u32 v237, s52, v231
  v_add_u32 v236, s52, v230
  v_lshlrev_b32 v48, 16, v96
  v_and_b32 v49, 0xffff0000, v96
  v_lshlrev_b32_e64 v50, 16, v97
  v_and_b32 v51, 0xffff0000, v97
  v_lshlrev_b32_e64 v52, 16, v98
  v_and_b32 v53, 0xffff0000, v98
  v_lshlrev_b32_e64 v54, 16, v99
  v_and_b32 v55, 0xffff0000, v99
  v_lshlrev_b32_e64 v56, 16, v100
  v_and_b32 v57, 0xffff0000, v100
  v_lshlrev_b32_e64 v58, 16, v101
  v_and_b32 v59, 0xffff0000, v101
  v_lshlrev_b32_e64 v60, 16, v102
  v_and_b32 v61, 0xffff0000, v102
  v_lshlrev_b32_e64 v62, 16, v103
  v_and_b32 v63, 0xffff0000, v103
  s_mov_b64 exec, 255
L_poll_31:
  buffer_load_dword v3, v244, s[28:31], s56 offen offset:8 sc1
  s_waitcnt vmcnt(1)
  v_cmp_ne_u32_e64 vcc, s7, v2
  s_cbranch_vccz L_poll_e_32
  buffer_load_dword v2, v244, s[28:31], s56 offen offset:8 sc1
  s_waitcnt vmcnt(1)
  v_cmp_ne_u32 vcc, s7, v3
  s_cbranch_vccz L_poll_e_32
  s_add_u32 s57, s57, 1
  s_cmp_le_u32 s57, 262144
  s_cbranch_scc1 L_poll_31
L_poll_e_32:
  s_mov_b64 exec, -1
  buffer_load_dwordx4 v[8:11], v246, s[28:31], s37 offen offset:0 sc1
  buffer_load_dwordx4 v[28:31], v246, s[28:31], s37 offen offset:1024 sc1
  s_add_u32 s37, s37, 262144
  buffer_load_dwordx4 v[32:35], v246, s[28:31], s37 offen offset:0 sc1
  buffer_load_dwordx4 v[36:39], v246, s[28:31], s37 offen offset:1024 sc1
  s_add_u32 s37, s37, 262144
  buffer_load_dwordx4 v[40:43], v246, s[28:31], s37 offen offset:0 sc1
  buffer_load_dwordx4 v[44:47], v246, s[28:31], s37 offen offset:1024 sc1
  s_barrier
  ds_read_b64_tr_b16 v[120:121], v239 offset:0
  ds_read_b64_tr_b16 v[122:123], v239 offset:3584
  ds_read_b64_tr_b16 v[124:125], v237 offset:0
  ds_read_b64_tr_b16 v[126:127], v237 offset:3584
  ds_read_b64_tr_b16 v[128:129], v239 offset:7168
  ds_read_b64_tr_b16 v[130:131], v239 offset:10752
  ds_read_b64_tr_b16 v[132:133], v237 offset:7168
  ds_read_b64_tr_b16 v[134:135], v237 offset:10752
  ds_read_b64_tr_b16 v[136:137], v239 offset:14336
  ds_read_b64_tr_b16 v[138:139], v239 offset:17920
  ds_read_b64_tr_b16 v[140:141], v237 offset:14336
  ds_read_b64_tr_b16 v[142:143], v237 offset:17920
  s_waitcnt lgkmcnt(8)
  v_mfma_f32_16x16x32_bf16 v[152:155], v[120:123], v[4:7], 0
  ds_read_b64_tr_b16 v[144:145], v239 offset:21504
  ds_read_b64_tr_b16 v[146:147], v239 offset:25088
  v_mfma_f32_16x16x32_bf16 v[156:159], v[124:127], v[4:7], 0
  ds_read_b64_tr_b16 v[148:149], v237 offset:21504
  ds_read_b64_tr_b16 v[150:151], v237 offset:25088
  s_waitcnt lgkmcnt(8)
  v_mfma_f32_16x16x32_bf16 v[152:155], v[128:131], v[4:7], v[152:155]
  ds_read_b64_tr_b16 v[120:121], v239 offset:28672
  ds_read_b64_tr_b16 v[122:123], v239 offset:32256
  v_mfma_f32_16x16x32_bf16 v[156:159], v[132:135], v[4:7], v[156:159]
  ds_read_b64_tr_b16 v[124:125], v237 offset:28672
  ds_read_b64_tr_b16 v[126:127], v237 offset:32256
  s_waitcnt lgkmcnt(8)
  v_mfma_f32_16x16x32_bf16 v[152:155], v[136:139], v[4:7], v[152:155]
  ds_read_b64_tr_b16 v[128:129], v239 offset:35840
  ds_read_b64_tr_b16 v[130:131], v239 offset:39424
  v_mfma_f32_16x16x32_bf16 v[156:159], v[140:143], v[4:7], v[156:159]
  ds_read_b64_tr_b16 v[132:133], v237 offset:35840
  ds_read_b64_tr_b16 v[134:135], v237 offset:39424
  s_waitcnt lgkmcnt(8)
  v_mfma_f32_16x16x32_bf16 v[152:155], v[144:147], v[4:7], v[152:155]
  v_mfma_f32_16x16x32_bf16 v[156:159], v[148:151], v[4:7], v[156:159]
  s_waitcnt lgkmcnt(4)
  v_mfma_f32_16x16x32_bf16 v[152:155], v[120:123], v[4:7], v[152:155]
  v_mfma_f32_16x16x32_bf16 v[156:159], v[124:127], v[4:7], v[156:159]
  s_waitcnt lgkmcnt(0)
  v_mfma_f32_16x16x32_bf16 v[152:155], v[128:131], v[4:7], v[152:155]
  v_mfma_f32_16x16x32_bf16 v[156:159], v[132:135], v[4:7], v[156:159]
  s_waitcnt vmcnt(5)
  v_mfma_f32_16x16x32_bf16 v[12:15], a[0:3], v[8:11], v[48:51]
  s_add_u32 s37, s37, 262144
  v_mfma_f32_16x16x32_bf16 v[16:19], a[4:7], v[8:11], v[52:55]
  buffer_load_dwordx4 v[64:67], v246, s[28:31], s37 offen offset:0 sc1
  v_mfma_f32_16x16x32_bf16 v[20:23], a[8:11], v[8:11], v[56:59]
  buffer_load_dwordx4 v[68:71], v246, s[28:31], s37 offen offset:1024 sc1
  v_mfma_f32_16x16x32_bf16 v[24:27], a[12:15], v[8:11], v[60:63]
  s_waitcnt vmcnt(6)
  v_mfma_f32_16x16x32_bf16 v[12:15], a[16:19], v[28:31], v[12:15]
  s_add_u32 s37, s37, 262144
  v_mfma_f32_16x16x32_bf16 v[16:19], a[20:23], v[28:31], v[16:19]
  buffer_load_dwordx4 v[72:75], v246, s[28:31], s37 offen offset:0 sc1
  v_mfma_f32_16x16x32_bf16 v[20:23], a[24:27], v[28:31], v[20:23]
  buffer_load_dwordx4 v[76:79], v246, s[28:31], s37 offen offset:1024 sc1
  v_mfma_f32_16x16x32_bf16 v[24:27], a[28:31], v[28:31], v[24:27]
  s_waitcnt vmcnt(7)
  v_mfma_f32_16x16x32_bf16 v[12:15], a[32:35], v[32:35], v[12:15]
  s_add_u32 s37, s37, 262144
  v_mfma_f32_16x16x32_bf16 v[16:19], a[36:39], v[32:35], v[16:19]
  buffer_load_dwordx4 v[80:83], v246, s[28:31], s37 offen offset:0 sc1
  v_mfma_f32_16x16x32_bf16 v[20:23], a[40:43], v[32:35], v[20:23]
  buffer_load_dwordx4 v[84:87], v246, s[28:31], s37 offen offset:1024 sc1
  v_mfma_f32_16x16x32_bf16 v[24:27], a[44:47], v[32:35], v[24:27]
  s_waitcnt vmcnt(8)
  v_mfma_f32_16x16x32_bf16 v[12:15], a[48:51], v[36:39], v[12:15]
  s_add_u32 s37, s37, 262144
  v_mfma_f32_16x16x32_bf16 v[16:19], a[52:55], v[36:39], v[16:19]
  buffer_load_dwordx4 v[104:107], v246, s[28:31], s37 offen offset:0 sc1
  v_mfma_f32_16x16x32_bf16 v[20:23], a[56:59], v[36:39], v[20:23]
  v_mfma_f32_16x16x32_bf16 v[24:27], a[60:63], v[36:39], v[24:27]
  s_waitcnt vmcnt(8)
  v_mfma_f32_16x16x32_bf16 v[12:15], a[64:67], v[40:43], v[12:15]
  buffer_load_dwordx4 v[108:111], v246, s[28:31], s37 offen offset:1024 sc1
  v_mfma_f32_16x16x32_bf16 v[16:19], a[68:71], v[40:43], v[16:19]
  v_mfma_f32_16x16x32_bf16 v[20:23], a[72:75], v[40:43], v[20:23]
  v_mfma_f32_16x16x32_bf16 v[24:27], a[76:79], v[40:43], v[24:27]
  s_waitcnt vmcnt(8)
  v_mfma_f32_16x16x32_bf16 v[12:15], a[80:83], v[44:47], v[12:15]
  s_add_u32 s37, s37, 262144
  v_mfma_f32_16x16x32_bf16 v[16:19], a[84:87], v[44:47], v[16:19]
  buffer_load_dwordx4 v[112:115], v246, s[28:31], s37 offen offset:0 sc1
  v_mfma_f32_16x16x32_bf16 v[20:23], a[88:91], v[44:47], v[20:23]
  v_mfma_f32_16x16x32_bf16 v[24:27], a[92:95], v[44:47], v[24:27]
  s_waitcnt vmcnt(8)
  v_mfma_f32_16x16x32_bf16 v[12:15], a[96:99], v[64:67], v[12:15]
  buffer_load_dwordx4 v[116:119], v246, s[28:31], s37 offen offset:1024 sc1
  v_mfma_f32_16x16x32_bf16 v[16:19], a[100:103], v[64:67], v[16:19]
  v_mfma_f32_16x16x32_bf16 v[20:23], a[104:107], v[64:67], v[20:23]
  v_mfma_f32_16x16x32_bf16 v[24:27], a[108:111], v[64:67], v[24:27]
  s_waitcnt vmcnt(8)
  v_mfma_f32_16x16x32_bf16 v[12:15], a[112:115], v[68:71], v[12:15]
  s_add_u32 m0, s15, 0
  v_mfma_f32_16x16x32_bf16 v[16:19], a[116:119], v[68:71], v[16:19]
  s_add_u32 s58, s47, 0
  v_mfma_f32_16x16x32_bf16 v[20:23], a[120:123], v[68:71], v[20:23]
  buffer_load_dwordx4 v243, s[24:27], s58 offen offset:0 lds
  v_mfma_f32_16x16x32_bf16 v[24:27], a[124:127], v[68:71], v[24:27]
  s_waitcnt vmcnt(8)
  v_mfma_f32_16x16x32_bf16 v[12:15], a[128:131], v[72:75], v[12:15]
  buffer_load_dwordx4 v242, s[24:27], s58 offen offset:1024 lds
  v_mfma_f32_16x16x32_bf16 v[16:19], a[132:135], v[72:75], v[16:19]
  v_mfma_f32_16x16x32_bf16 v[20:23], a[136:139], v[72:75], v[20:23]
  v_mfma_f32_16x16x32_bf16 v[24:27], a[140:143], v[72:75], v[24:27]
  s_waitcnt vmcnt(8)
  v_mfma_f32_16x16x32_bf16 v[12:15], a[144:147], v[76:79], v[12:15]
  buffer_load_dwordx4 v241, s[24:27], s58 offen offset:2048 lds
  v_mfma_f32_16x16x32_bf16 v[16:19], a[148:151], v[76:79], v[16:19]
  v_mfma_f32_16x16x32_bf16 v[20:23], a[152:155], v[76:79], v[20:23]
  v_mfma_f32_16x16x32_bf16 v[24:27], a[156:159], v[76:79], v[24:27]
  s_waitcnt vmcnt(8)
  v_mfma_f32_16x16x32_bf16 v[12:15], a[160:163], v[80:83], v[12:15]
  buffer_load_dwordx4 v240, s[24:27], s58 offen offset:3072 lds
  v_mfma_f32_16x16x32_bf16 v[16:19], a[164:167], v[80:83], v[16:19]
  v_mfma_f32_16x16x32_bf16 v[20:23], a[168:171], v[80:83], v[20:23]
  v_mfma_f32_16x16x32_bf16 v[24:27], a[172:175], v[80:83], v[24:27]
  s_waitcnt vmcnt(8)
  v_mfma_f32_16x16x32_bf16 v[12:15], a[176:179], v[84:87], v[12:15]
  s_add_u32 m0, s15, 4096
  v_mfma_f32_16x16x32_bf16 v[16:19], a[180:183], v[84:87], v[16:19]
  s_add_u32 s58, s47, 32768
  v_mfma_f32_16x16x32_bf16 v[20:23], a[184:187], v[84:87], v[20:23]
  buffer_load_dwordx4 v243, s[24:27], s58 offen offset:0 lds
  v_mfma_f32_16x16x32_bf16 v[24:27], a[188:191], v[84:87], v[24:27]
  s_waitcnt vmcnt(8)
  v_mfma_f32_16x16x32_bf16 v[12:15], a[192:195], v[104:107], v[12:15]
  buffer_load_dwordx4 v242, s[24:27], s58 offen offset:1024 lds
  v_mfma_f32_16x16x32_bf16 v[16:19], a[196:199], v[104:107], v[16:19]
  v_mfma_f32_16x16x32_bf16 v[20:23], a[200:203], v[104:107], v[20:23]
  v_mfma_f32_16x16x32_bf16 v[24:27], a[204:207], v[104:107], v[24:27]
  s_waitcnt vmcnt(8)
  v_mfma_f32_16x16x32_bf16 v[12:15], a[208:211], v[108:111], v[12:15]
  buffer_load_dwordx4 v241, s[24:27], s58 offen offset:2048 lds
  v_mfma_f32_16x16x32_bf16 v[16:19], a[212:215], v[108:111], v[16:19]
  v_mfma_f32_16x16x32_bf16 v[20:23], a[216:219], v[108:111], v[20:23]
  v_mfma_f32_16x16x32_bf16 v[24:27], a[220:223], v[108:111], v[24:27]
  s_waitcnt vmcnt(8)
  v_mfma_f32_16x16x32_bf16 v[12:15], a[224:227], v[112:115], v[12:15]
  buffer_load_dwordx4 v240, s[24:27], s58 offen offset:3072 lds
  v_mfma_f32_16x16x32_bf16 v[16:19], a[228:231], v[112:115], v[16:19]
  v_mfma_f32_16x16x32_bf16 v[20:23], a[232:235], v[112:115], v[20:23]
  v_mfma_f32_16x16x32_bf16 v[24:27], a[236:239], v[112:115], v[24:27]
  s_waitcnt vmcnt(8)
  v_mfma_f32_16x16x32_bf16 v[12:15], a[240:243], v[116:119], v[12:15]
  v_mfma_f32_16x16x32_bf16 v[16:19], a[244:247], v[116:119], v[16:19]
  v_mfma_f32_16x16x32_bf16 v[20:23], a[248:251], v[116:119], v[20:23]
  v_mfma_f32_16x16x32_bf16 v[24:27], a[252:255], v[116:119], v[24:27]
  s_nop 4
  v_cvt_pk_bf16_f32 v96, v12, v13
  v_cvt_pk_bf16_f32 v97, v14, v15
  v_cvt_pk_bf16_f32 v98, v16, v17
  v_cvt_pk_bf16_f32 v99, v18, v19
  v_cvt_pk_bf16_f32 v100, v20, v21
  v_cvt_pk_bf16_f32 v101, v22, v23
  v_cvt_pk_bf16_f32 v102, v24, v25
  v_cvt_pk_bf16_f32 v103, v26, v27
  buffer_store_dwordx4 v[96:99], v246, s[28:31], s38 offen offset:0 sc1
  buffer_store_dwordx4 v[100:103], v246, s[28:31], s38 offen offset:1024 sc1
  v_pk_add_f32 v[8:9], v[12:13], v[14:15]
  v_pk_add_f32 v[10:11], v[16:17], v[18:19]
  v_pk_mul_f32 v[28:29], v[12:13], v[12:13]
  v_pk_mul_f32 v[30:31], v[14:15], v[14:15]
  v_pk_add_f32 v[8:9], v[8:9], v[20:21]
  v_pk_add_f32 v[10:11], v[10:11], v[22:23]
  v_pk_fma_f32 v[28:29], v[16:17], v[16:17], v[28:29]
  v_pk_fma_f32 v[30:31], v[18:19], v[18:19], v[30:31]
  v_pk_fma_f32 v[28:29], v[20:21], v[20:21], v[28:29]
  v_pk_fma_f32 v[30:31], v[22:23], v[22:23], v[30:31]
  v_pk_fma_f32 v[28:29], v[24:25], v[24:25], v[28:29]
  v_pk_fma_f32 v[30:31], v[26:27], v[26:27], v[30:31]
  v_pk_add_f32 v[8:9], v[8:9], v[24:25]
  v_pk_add_f32 v[10:11], v[10:11], v[26:27]
  v_pk_add_f32 v[28:29], v[28:29], v[30:31]
  v_pk_add_f32 v[8:9], v[8:9], v[10:11]
  v_add_f32 v28, v28, v29
  v_add_f32 v8, v8, v9
  s_nop 1
  v_permlane32_swap_b32 v8, v28
  v_add_f32 v8, v8, v28
  v_mov_b32 v9, v8
  s_nop 1
  v_permlane16_swap_b32 v8, v9
  v_add_f32 v8, v8, v9
  v_mov_b32 v9, v8
  s_nop 1
  v_permlane32_swap_b32 v8, v9
  s_mov_b64 exec, 0xffff
  buffer_store_dwordx2 v[8:9], v218, s[28:31], s39 offen sc1
  s_mov_b64 exec, -1
  s_lshr_b32 s51, s2, 3
  s_lshl_b32 s51, s51, 2
  s_add_u32 s51, s51, s3
  s_lshl_b32 s51, s51, 8
  v_lshl_add_u32 v255, v0, 7, s51
  s_getpc_b64 s[68:69]
L_ct1:
  v_min_u32 v255, L_last-L_ct1-64, v255
  v_mov_b32_e64 v235, s69
  v_add_co_u32 v234, vcc, s68, v255
  s_nop 1
  v_addc_co_u32 v235, vcc, 0, v235, vcc
  s_mov_b64 exec, 3
  global_load_dword v250, v[234:235], off
  s_mov_b64 exec, -1
  ds_read_b64_tr_b16 v[136:137], v239 offset:43008
  ds_read_b64_tr_b16 v[138:139], v239 offset:46592
  ds_read_b64_tr_b16 v[140:141], v237 offset:43008
  ds_read_b64_tr_b16 v[142:143], v237 offset:46592
  ds_read_b64_tr_b16 v[144:145], v239 offset:50176
  ds_read_b64_tr_b16 v[146:147], v239 offset:53760
  ds_read_b64_tr_b16 v[148:149], v237 offset:50176
  ds_read_b64_tr_b16 v[150:151], v237 offset:53760
  ds_read_b64_tr_b16 v[120:121], v238 offset:0
  ds_read_b64_tr_b16 v[122:123], v238 offset:3584
  ds_read_b64_tr_b16 v[124:125], v236 offset:0
  ds_read_b64_tr_b16 v[126:127], v236 offset:3584
  s_nop 0
  v_accvgpr_write_b32 a224, v96
  v_accvgpr_write_b32 a225, v97
  v_accvgpr_write_b32 a226, v98
  v_accvgpr_write_b32 a227, v99
  v_accvgpr_write_b32 a228, v100
  v_accvgpr_write_b32 a229, v101
  v_accvgpr_write_b32 a230, v102
  v_accvgpr_write_b32 a231, v103
  v_accvgpr_write_b32 a232, v188
  v_accvgpr_write_b32 a233, v189
  s_waitcnt lgkmcnt(8)
  v_mfma_f32_16x16x32_bf16 v[152:155], v[136:139], v[4:7], v[152:155]
  ds_read_b64_tr_b16 v[128:129], v238 offset:7168
  ds_read_b64_tr_b16 v[130:131], v238 offset:10752
  v_mfma_f32_16x16x32_bf16 v[156:159], v[140:143], v[4:7], v[156:159]
  ds_read_b64_tr_b16 v[132:133], v236 offset:7168
  ds_read_b64_tr_b16 v[134:135], v236 offset:10752
  s_waitcnt lgkmcnt(8)
  v_mfma_f32_16x16x32_bf16 v[152:155], v[144:147], v[4:7], v[152:155]
  ds_read_b64_tr_b16 v[136:137], v238 offset:14336
  ds_read_b64_tr_b16 v[138:139], v238 offset:17920
  v_mfma_f32_16x16x32_bf16 v[156:159], v[148:151], v[4:7], v[156:159]
  ds_read_b64_tr_b16 v[140:141], v236 offset:14336
  ds_read_b64_tr_b16 v[142:143], v236 offset:17920
  s_waitcnt lgkmcnt(8)
  v_mfma_f32_16x16x32_bf16 v[152:155], v[120:123], v[4:7], v[152:155]
  ds_read_b64_tr_b16 v[144:145], v238 offset:21504
  ds_read_b64_tr_b16 v[146:147], v238 offset:25088
  v_mfma_f32_16x16x32_bf16 v[156:159], v[124:127], v[4:7], v[156:159]
  ds_read_b64_tr_b16 v[148:149], v236 offset:21504
  ds_read_b64_tr_b16 v[150:151], v236 offset:25088
  s_waitcnt lgkmcnt(8)
  v_mfma_f32_16x16x32_bf16 v[152:155], v[128:131], v[4:7], v[152:155]
  ds_read_b64_tr_b16 v[120:121], v238 offset:28672
  ds_read_b64_tr_b16 v[122:123], v238 offset:32256
  v_mfma_f32_16x16x32_bf16 v[156:159], v[132:135], v[4:7], v[156:159]
  ds_read_b64_tr_b16 v[124:125], v236 offset:28672
  ds_read_b64_tr_b16 v[126:127], v236 offset:32256
  s_waitcnt lgkmcnt(8)
  v_mfma_f32_16x16x32_bf16 v[152:155], v[136:139], v[4:7], v[152:155]
  ds_read_b64_tr_b16 v[128:129], v238 offset:35840
  ds_read_b64_tr_b16 v[130:131], v238 offset:39424
  v_mfma_f32_16x16x32_bf16 v[156:159], v[140:143], v[4:7], v[156:159]
  ds_read_b64_tr_b16 v[132:133], v236 offset:35840
  ds_read_b64_tr_b16 v[134:135], v236 offset:39424
  s_waitcnt lgkmcnt(8)
  v_mfma_f32_16x16x32_bf16 v[152:155], v[144:147], v[4:7], v[152:155]
  ds_read_b64_tr_b16 v[136:137], v238 offset:43008
  ds_read_b64_tr_b16 v[138:139], v238 offset:46592
  v_mfma_f32_16x16x32_bf16 v[156:159], v[148:151], v[4:7], v[156:159]
  ds_read_b64_tr_b16 v[140:141], v236 offset:43008
  ds_read_b64_tr_b16 v[142:143], v236 offset:46592
  s_waitcnt lgkmcnt(8)
  v_mfma_f32_16x16x32_bf16 v[152:155], v[120:123], v[4:7], v[152:155]
  ds_read_b64_tr_b16 v[144:145], v238 offset:50176
  ds_read_b64_tr_b16 v[146:147], v238 offset:53760
  v_mfma_f32_16x16x32_bf16 v[156:159], v[124:127], v[4:7], v[156:159]
  ds_read_b64_tr_b16 v[148:149], v236 offset:50176
  ds_read_b64_tr_b16 v[150:151], v236 offset:53760
  s_waitcnt lgkmcnt(8)
  v_mfma_f32_16x16x32_bf16 v[152:155], v[128:131], v[4:7], v[152:155]
  v_mfma_f32_16x16x32_bf16 v[156:159], v[132:135], v[4:7], v[156:159]
  s_waitcnt lgkmcnt(4)
  v_mfma_f32_16x16x32_bf16 v[152:155], v[136:139], v[4:7], v[152:155]
  v_mfma_f32_16x16x32_bf16 v[156:159], v[140:143], v[4:7], v[156:159]
  s_waitcnt lgkmcnt(0)
  v_mfma_f32_16x16x32_bf16 v[152:155], v[144:147], v[4:7], v[152:155]
  v_mfma_f32_16x16x32_bf16 v[156:159], v[148:151], v[4:7], v[156:159]
  v_cmp_gt_u32 vcc, 8, v249
  s_waitcnt vmcnt(8)
  ds_read_b64_tr_b16 a[0:1], v229 offset:0
  ds_read_b64_tr_b16 a[2:3], v229 offset:2048
  ds_read_b64_tr_b16 a[4:5], v221 offset:0
  ds_read_b64_tr_b16 a[6:7], v221 offset:2048
  ds_read_b64_tr_b16 a[8:9], v220 offset:0
  ds_read_b64_tr_b16 a[10:11], v220 offset:2048
  ds_read_b64_tr_b16 a[12:13], v219 offset:0
  ds_read_b64_tr_b16 a[14:15], v219 offset:2048
  v_cndmask_b32 v88, v156, v152, vcc
  v_cndmask_b32 v89, v157, v153, vcc
  v_cndmask_b32 v90, v158, v154, vcc
  v_cndmask_b32 v91, v159, v155, vcc
  s_mov_b32 exec_lo, 0x01010101
  s_mov_b32 exec_hi, 0x01010101
  ds_write_b128 v192, v[88:91] offset:0
  ds_write_b128 v192, v[92:95] offset:16
  s_mov_b64 exec, -1
  s_waitcnt vmcnt(4)
  ds_read_b64_tr_b16 a[16:17], v229 offset:4096
  ds_read_b64_tr_b16 a[18:19], v229 offset:6144
  ds_read_b64_tr_b16 a[20:21], v221 offset:4096
  ds_read_b64_tr_b16 a[22:23], v221 offset:6144
  ds_read_b64_tr_b16 a[24:25], v220 offset:4096
  ds_read_b64_tr_b16 a[26:27], v220 offset:6144
  ds_read_b64_tr_b16 a[28:29], v219 offset:4096
  ds_read_b64_tr_b16 a[30:31], v219 offset:6144
  s_waitcnt vmcnt(1) lgkmcnt(0)
  s_barrier
  s_cmp_lg_u32 s3, 0
  s_cbranch_scc1 L_fl_skip_33
  s_mov_b64 exec, 1
  s_cmp_eq_u32 s48, 0
  s_cbranch_scc1 L_fl_slow_34
  buffer_store_dword v245, v244, s[28:31], s36 offen offset:12
L_fl_skip_33:
  s_mov_b64 exec, -1
  ds_read_b128 v[88:91], v187 offset:0
  ds_read_b128 v[92:95], v187 offset:16
  s_add_u32 m0, s15, 0
  s_add_u32 s58, s62, 0
  buffer_load_dwordx4 v243, s[24:27], s58 offen offset:0 lds
  buffer_load_dwordx4 v242, s[24:27], s58 offen offset:1024 lds
  buffer_load_dwordx4 v241, s[24:27], s58 offen offset:2048 lds
  buffer_load_dwordx4 v240, s[24:27], s58 offen offset:3072 lds
  s_add_u32 m0, s15, 4096
  s_add_u32 s58, s62, 32768
  buffer_load_dwordx4 v243, s[24:27], s58 offen offset:0 lds
  buffer_load_dwordx4 v242, s[24:27], s58 offen offset:1024 lds
  buffer_load_dwordx4 v241, s[24:27], s58 offen offset:2048 lds
  buffer_load_dwordx4 v240, s[24:27], s58 offen offset:3072 lds
  s_mov_b64 exec, 65535
  s_mov_b32 s57, 0
  buffer_load_dword v2, v244, s[28:31], s90 offen offset:12 sc1
  s_mov_b64 exec, -1
  s_add_u32 s8, s92, 0
  s_lshl_b32 s14, s3, 16
  s_add_u32 s14, s14, s42
  s_mov_b64 exec, 65535
L_poll_35:
  buffer_load_dword v3, v244, s[28:31], s90 offen offset:12 sc1
  s_waitcnt vmcnt(1)
  v_cmp_ne_u32 vcc, s7, v2
  s_cbranch_vccz L_poll_e_36
  buffer_load_dword v2, v244, s[28:31], s90 offen offset:12 sc1
  s_waitcnt vmcnt(1)
  v_cmp_ne_u32 vcc, s7, v3
  s_cbranch_vccz L_poll_e_36
  s_add_u32 s57, s57, 1
  s_cmp_le_u32 s57, 262144
  s_cbranch_scc1 L_poll_35
L_poll_e_36:
  s_mov_b64 exec, -1
  s_add_u32 s53, s8, 0
  s_and_b32 s53, s53, 3
  s_and_b32 s54, s53, 2
  s_add_u32 s53, s53, s54
  s_lshl_b32 s53, s53, 12
  s_add_u32 s53, s53, s14
  buffer_load_dwordx4 v[4:7], v246, s[28:31], s53 offen offset:0 sc1
  ds_read_b64_tr_b16 v[196:197], v231 offset:0
  ds_read_b64_tr_b16 v[198:199], v231 offset:3584
  s_add_u32 s54, s53, 32768
  buffer_load_dwordx4 v[8:11], v246, s[28:31], s54 offen offset:0 sc1
  ds_read_b64_tr_b16 v[200:201], v231 offset:32
  ds_read_b64_tr_b16 v[202:203], v231 offset:3616
  buffer_load_dwordx4 v[12:15], v246, s[28:31], s53 offen offset:1024 sc1
  ds_read_b64_tr_b16 v[204:205], v231 offset:64
  ds_read_b64_tr_b16 v[206:207], v231 offset:3648
  buffer_load_dwordx4 v[16:19], v246, s[28:31], s54 offen offset:1024 sc1
  ds_read_b64_tr_b16 v[208:209], v231 offset:96
  ds_read_b64_tr_b16 v[210:211], v231 offset:3680
  buffer_load_dwordx4 v[20:23], v246, s[28:31], s53 offen offset:2048 sc1
  ds_read_b64_tr_b16 v[212:213], v231 offset:128
  ds_read_b64_tr_b16 v[214:215], v231 offset:3712
  buffer_load_dwordx4 v[24:27], v246, s[28:31], s54 offen offset:2048 sc1
  ds_read_b64_tr_b16 v[224:225], v231 offset:160
  ds_read_b64_tr_b16 v[226:227], v231 offset:3744
  buffer_load_dwordx4 v[28:31], v246, s[28:31], s53 offen offset:3072 sc1
  ds_read_b64_tr_b16 v[232:233], v231 offset:192
  ds_read_b64_tr_b16 v[234:235], v231 offset:3776
  s_waitcnt lgkmcnt(14)
  s_barrier
  s_waitcnt vmcnt(5)
  s_waitcnt lgkmcnt(6)
  v_mfma_f32_16x16x32_bf16 v[140:143], v[196:199], v[4:7], 0
  ds_read_b64_tr_b16 v[236:237], v231 offset:7168
  v_mfma_f32_16x16x32_bf16 v[144:147], v[196:199], v[8:11], 0
  ds_read_b64_tr_b16 v[238:239], v231 offset:10752
  v_mfma_f32_16x16x32_bf16 v[148:151], v[200:203], v[4:7], 0
  ds_read_b64_tr_b16 v[196:197], v231 offset:7200
  buffer_load_dwordx4 v[32:35], v246, s[28:31], s54 offen offset:3072 sc1
  v_mfma_f32_16x16x32_bf16 v[152:155], v[200:203], v[8:11], 0
  ds_read_b64_tr_b16 v[198:199], v231 offset:10784
  v_mfma_f32_16x16x32_bf16 v[156:159], v[204:207], v[4:7], 0
  ds_read_b64_tr_b16 v[200:201], v231 offset:7232
  v_mfma_f32_16x16x32_bf16 v[160:163], v[204:207], v[8:11], 0
  ds_read_b64_tr_b16 v[202:203], v231 offset:10816
  v_mfma_f32_16x16x32_bf16 v[164:167], v[208:211], v[4:7], 0
  s_add_u32 s53, s8, 1
  ds_read_b64_tr_b16 v[204:205], v231 offset:7264
  s_and_b32 s53, s53, 3
  ds_read_b64_tr_b16 v[206:207], v231 offset:10848
  s_and_b32 s54, s53, 2
  v_mfma_f32_16x16x32_bf16 v[168:171], v[208:211], v[8:11], 0
  s_add_u32 s53, s53, s54
  s_lshl_b32 s53, s53, 12
  s_add_u32 s53, s53, s14
  buffer_load_dwordx4 v[36:39], v246, s[28:31], s53 offen offset:0 sc1
  s_waitcnt lgkmcnt(6)
  v_mfma_f32_16x16x32_bf16 v[172:175], v[212:215], v[4:7], 0
  ds_read_b64_tr_b16 v[208:209], v231 offset:7296
  v_mfma_f32_16x16x32_bf16 v[176:179], v[212:215], v[8:11], 0
  ds_read_b64_tr_b16 v[210:211], v231 offset:10880
  v_mfma_f32_16x16x32_bf16 v[180:183], v[224:227], v[4:7], 0
  s_add_u32 s54, s53, 32768
  ds_read_b64_tr_b16 v[212:213], v231 offset:7328
  v_mfma_f32_16x16x32_bf16 v[184:187], v[224:227], v[8:11], 0
  buffer_load_dwordx4 v[40:43], v246, s[28:31], s54 offen offset:0 sc1
  ds_read_b64_tr_b16 v[214:215], v231 offset:10912
  v_mfma_f32_16x16x32_bf16 v[188:191], v[232:235], v[4:7], 0
  ds_read_b64_tr_b16 v[224:225], v231 offset:7360
  v_mfma_f32_16x16x32_bf16 v[192:195], v[232:235], v[8:11], 0
  ds_read_b64_tr_b16 v[226:227], v231 offset:10944
  s_waitcnt vmcnt(6)
  v_mfma_f32_16x16x32_bf16 v[140:143], v[236:239], v[12:15], v[140:143]
  ds_read_b64_tr_b16 v[232:233], v231 offset:14336
  buffer_load_dwordx4 v[44:47], v246, s[28:31], s53 offen offset:1024 sc1
  v_mfma_f32_16x16x32_bf16 v[144:147], v[236:239], v[16:19], v[144:147]
  ds_read_b64_tr_b16 v[234:235], v231 offset:17920
  s_waitcnt lgkmcnt(6)
  v_mfma_f32_16x16x32_bf16 v[148:151], v[196:199], v[12:15], v[148:151]
  ds_read_b64_tr_b16 v[236:237], v231 offset:14368
  v_mfma_f32_16x16x32_bf16 v[152:155], v[196:199], v[16:19], v[152:155]
  ds_read_b64_tr_b16 v[238:239], v231 offset:17952
  v_mfma_f32_16x16x32_bf16 v[156:159], v[200:203], v[12:15], v[156:159]
  ds_read_b64_tr_b16 v[196:197], v231 offset:14400
  buffer_load_dwordx4 v[48:51], v246, s[28:31], s54 offen offset:1024 sc1
  v_mfma_f32_16x16x32_bf16 v[160:163], v[200:203], v[16:19], v[160:163]
  ds_read_b64_tr_b16 v[198:199], v231 offset:17984
  v_mfma_f32_16x16x32_bf16 v[164:167], v[204:207], v[12:15], v[164:167]
  ds_read_b64_tr_b16 v[200:201], v231 offset:14432
  v_mfma_f32_16x16x32_bf16 v[168:171], v[204:207], v[16:19], v[168:171]
  ds_read_b64_tr_b16 v[202:203], v231 offset:18016
  v_mfma_f32_16x16x32_bf16 v[172:175], v[208:211], v[12:15], v[172:175]
  ds_read_b64_tr_b16 v[204:205], v231 offset:14464
  buffer_load_dwordx4 v[52:55], v246, s[28:31], s53 offen offset:2048 sc1
  v_mfma_f32_16x16x32_bf16 v[176:179], v[208:211], v[16:19], v[176:179]
  ds_read_b64_tr_b16 v[206:207], v231 offset:18048
  s_waitcnt lgkmcnt(6)
  v_mfma_f32_16x16x32_bf16 v[180:183], v[212:215], v[12:15], v[180:183]
  ds_read_b64_tr_b16 v[208:209], v231 offset:14496
  v_mfma_f32_16x16x32_bf16 v[184:187], v[212:215], v[16:19], v[184:187]
  ds_read_b64_tr_b16 v[210:211], v231 offset:18080
  v_mfma_f32_16x16x32_bf16 v[188:191], v[224:227], v[12:15], v[188:191]
  ds_read_b64_tr_b16 v[212:213], v231 offset:14528
  buffer_load_dwordx4 v[56:59], v246, s[28:31], s54 offen offset:2048 sc1
  v_mfma_f32_16x16x32_bf16 v[192:195], v[224:227], v[16:19], v[192:195]
  ds_read_b64_tr_b16 v[214:215], v231 offset:18112
  s_waitcnt vmcnt(8)
  v_mfma_f32_16x16x32_bf16 v[140:143], v[232:235], v[20:23], v[140:143]
  ds_read_b64_tr_b16 v[224:225], v231 offset:21504
  v_mfma_f32_16x16x32_bf16 v[144:147], v[232:235], v[24:27], v[144:147]
  ds_read_b64_tr_b16 v[226:227], v231 offset:25088
  v_mfma_f32_16x16x32_bf16 v[148:151], v[236:239], v[20:23], v[148:151]
  ds_read_b64_tr_b16 v[232:233], v231 offset:21536
  buffer_load_dwordx4 v[60:63], v246, s[28:31], s53 offen offset:3072 sc1
  v_mfma_f32_16x16x32_bf16 v[152:155], v[236:239], v[24:27], v[152:155]
  ds_read_b64_tr_b16 v[234:235], v231 offset:25120
  s_waitcnt lgkmcnt(6)
  v_mfma_f32_16x16x32_bf16 v[156:159], v[196:199], v[20:23], v[156:159]
  ds_read_b64_tr_b16 v[236:237], v231 offset:21568
  v_mfma_f32_16x16x32_bf16 v[160:163], v[196:199], v[24:27], v[160:163]
  ds_read_b64_tr_b16 v[238:239], v231 offset:25152
  v_mfma_f32_16x16x32_bf16 v[164:167], v[200:203], v[20:23], v[164:167]
  ds_read_b64_tr_b16 v[196:197], v231 offset:21600
  buffer_load_dwordx4 v[64:67], v246, s[28:31], s54 offen offset:3072 sc1
  v_mfma_f32_16x16x32_bf16 v[168:171], v[200:203], v[24:27], v[168:171]
  ds_read_b64_tr_b16 v[198:199], v231 offset:25184
  v_mfma_f32_16x16x32_bf16 v[172:175], v[204:207], v[20:23], v[172:175]
  ds_read_b64_tr_b16 v[200:201], v231 offset:21632
  v_mfma_f32_16x16x32_bf16 v[176:179], v[204:207], v[24:27], v[176:179]
  ds_read_b64_tr_b16 v[202:203], v231 offset:25216
  v_mfma_f32_16x16x32_bf16 v[180:183], v[208:211], v[20:23], v[180:183]
  s_add_u32 s53, s8, 2
  ds_read_b64_tr_b16 v[204:205], v231 offset:21664
  s_and_b32 s53, s53, 3
  ds_read_b64_tr_b16 v[206:207], v231 offset:25248
  s_and_b32 s54, s53, 2
  v_mfma_f32_16x16x32_bf16 v[184:187], v[208:211], v[24:27], v[184:187]
  s_add_u32 s53, s53, s54
  s_lshl_b32 s53, s53, 12
  s_add_u32 s53, s53, s14
  buffer_load_dwordx4 v[68:71], v246, s[28:31], s53 offen offset:0 sc1
  s_waitcnt lgkmcnt(6)
  v_mfma_f32_16x16x32_bf16 v[188:191], v[212:215], v[20:23], v[188:191]
  ds_read_b64_tr_b16 v[208:209], v231 offset:21696
  v_mfma_f32_16x16x32_bf16 v[192:195], v[212:215], v[24:27], v[192:195]
  ds_read_b64_tr_b16 v[210:211], v231 offset:25280
  s_waitcnt vmcnt(9)
  v_mfma_f32_16x16x32_bf16 v[140:143], v[224:227], v[28:31], v[140:143]
  s_add_u32 s54, s53, 32768
  ds_read_b64_tr_b16 v[212:213], v231 offset:28672
  v_mfma_f32_16x16x32_bf16 v[144:147], v[224:227], v[32:35], v[144:147]
  buffer_load_dwordx4 v[72:75], v246, s[28:31], s54 offen offset:0 sc1
  ds_read_b64_tr_b16 v[214:215], v231 offset:32256
  v_mfma_f32_16x16x32_bf16 v[148:151], v[232:235], v[28:31], v[148:151]
  ds_read_b64_tr_b16 v[224:225], v231 offset:28704
  v_mfma_f32_16x16x32_bf16 v[152:155], v[232:235], v[32:35], v[152:155]
  ds_read_b64_tr_b16 v[226:227], v231 offset:32288
  v_mfma_f32_16x16x32_bf16 v[156:159], v[236:239], v[28:31], v[156:159]
  ds_read_b64_tr_b16 v[232:233], v231 offset:28736
  buffer_load_dwordx4 v[76:79], v246, s[28:31], s53 offen offset:1024 sc1
  v_mfma_f32_16x16x32_bf16 v[160:163], v[236:239], v[32:35], v[160:163]
  ds_read_b64_tr_b16 v[234:235], v231 offset:32320
  s_waitcnt lgkmcnt(6)
  v_mfma_f32_16x16x32_bf16 v[164:167], v[196:199], v[28:31], v[164:167]
  ds_read_b64_tr_b16 v[236:237], v231 offset:28768
  v_mfma_f32_16x16x32_bf16 v[168:171], v[196:199], v[32:35], v[168:171]
  ds_read_b64_tr_b16 v[238:239], v231 offset:32352
  v_mfma_f32_16x16x32_bf16 v[172:175], v[200:203], v[28:31], v[172:175]
  ds_read_b64_tr_b16 v[196:197], v231 offset:28800
  buffer_load_dwordx4 v[80:83], v246, s[28:31], s54 offen offset:1024 sc1
  v_mfma_f32_16x16x32_bf16 v[176:179], v[200:203], v[32:35], v[176:179]
  ds_read_b64_tr_b16 v[198:199], v231 offset:32384
  v_mfma_f32_16x16x32_bf16 v[180:183], v[204:207], v[28:31], v[180:183]
  ds_read_b64_tr_b16 v[200:201], v231 offset:28832
  v_mfma_f32_16x16x32_bf16 v[184:187], v[204:207], v[32:35], v[184:187]
  ds_read_b64_tr_b16 v[202:203], v231 offset:32416
  v_mfma_f32_16x16x32_bf16 v[188:191], v[208:211], v[28:31], v[188:191]
  ds_read_b64_tr_b16 v[204:205], v231 offset:28864
  buffer_load_dwordx4 v[84:87], v246, s[28:31], s53 offen offset:2048 sc1
  v_mfma_f32_16x16x32_bf16 v[192:195], v[208:211], v[32:35], v[192:195]
  ds_read_b64_tr_b16 v[206:207], v231 offset:32448
  s_waitcnt vmcnt(11)
  s_waitcnt lgkmcnt(6)
  v_mfma_f32_16x16x32_bf16 v[140:143], v[212:215], v[36:39], v[140:143]
  ds_read_b64_tr_b16 v[208:209], v231 offset:35840
  v_mfma_f32_16x16x32_bf16 v[144:147], v[212:215], v[40:43], v[144:147]
  ds_read_b64_tr_b16 v[210:211], v231 offset:39424
  v_mfma_f32_16x16x32_bf16 v[148:151], v[224:227], v[36:39], v[148:151]
  ds_read_b64_tr_b16 v[212:213], v231 offset:35872
  buffer_load_dwordx4 v[96:99], v246, s[28:31], s54 offen offset:2048 sc1
  v_mfma_f32_16x16x32_bf16 v[152:155], v[224:227], v[40:43], v[152:155]
  ds_read_b64_tr_b16 v[214:215], v231 offset:39456
  v_mfma_f32_16x16x32_bf16 v[156:159], v[232:235], v[36:39], v[156:159]
  ds_read_b64_tr_b16 v[224:225], v231 offset:35904
  v_mfma_f32_16x16x32_bf16 v[160:163], v[232:235], v[40:43], v[160:163]
  ds_read_b64_tr_b16 v[226:227], v231 offset:39488
  v_mfma_f32_16x16x32_bf16 v[164:167], v[236:239], v[36:39], v[164:167]
  ds_read_b64_tr_b16 v[232:233], v231 offset:35936
  buffer_load_dwordx4 v[100:103], v246, s[28:31], s53 offen offset:3072 sc1
  v_mfma_f32_16x16x32_bf16 v[168:171], v[236:239], v[40:43], v[168:171]
  ds_read_b64_tr_b16 v[234:235], v231 offset:39520
  s_waitcnt lgkmcnt(6)
  v_mfma_f32_16x16x32_bf16 v[172:175], v[196:199], v[36:39], v[172:175]
  ds_read_b64_tr_b16 v[236:237], v231 offset:35968
  v_mfma_f32_16x16x32_bf16 v[176:179], v[196:199], v[40:43], v[176:179]
  ds_read_b64_tr_b16 v[238:239], v231 offset:39552
  v_mfma_f32_16x16x32_bf16 v[180:183], v[200:203], v[36:39], v[180:183]
  ds_read_b64_tr_b16 v[196:197], v231 offset:36000
  buffer_load_dwordx4 v[104:107], v246, s[28:31], s54 offen offset:3072 sc1
  v_mfma_f32_16x16x32_bf16 v[184:187], v[200:203], v[40:43], v[184:187]
  ds_read_b64_tr_b16 v[198:199], v231 offset:39584
  v_mfma_f32_16x16x32_bf16 v[188:191], v[204:207], v[36:39], v[188:191]
  ds_read_b64_tr_b16 v[200:201], v231 offset:36032
  v_mfma_f32_16x16x32_bf16 v[192:195], v[204:207], v[40:43], v[192:195]
  ds_read_b64_tr_b16 v[202:203], v231 offset:39616
  s_waitcnt vmcnt(12)
  v_mfma_f32_16x16x32_bf16 v[140:143], v[208:211], v[44:47], v[140:143]
  s_add_u32 s53, s8, 3
  ds_read_b64_tr_b16 v[204:205], v231 offset:43008
  s_and_b32 s53, s53, 3
  ds_read_b64_tr_b16 v[206:207], v231 offset:46592
  s_and_b32 s54, s53, 2
  v_mfma_f32_16x16x32_bf16 v[144:147], v[208:211], v[48:51], v[144:147]
  s_add_u32 s53, s53, s54
  s_lshl_b32 s53, s53, 12
  s_add_u32 s53, s53, s14
  buffer_load_dwordx4 v[108:111], v246, s[28:31], s53 offen offset:0 sc1
  s_waitcnt lgkmcnt(6)
  v_mfma_f32_16x16x32_bf16 v[148:151], v[212:215], v[44:47], v[148:151]
  ds_read_b64_tr_b16 v[208:209], v231 offset:43040
  v_mfma_f32_16x16x32_bf16 v[152:155], v[212:215], v[48:51], v[152:155]
  ds_read_b64_tr_b16 v[210:211], v231 offset:46624
  v_mfma_f32_16x16x32_bf16 v[156:159], v[224:227], v[44:47], v[156:159]
  s_add_u32 s54, s53, 32768
  ds_read_b64_tr_b16 v[212:213], v231 offset:43072
  v_mfma_f32_16x16x32_bf16 v[160:163], v[224:227], v[48:51], v[160:163]
  buffer_load_dwordx4 v[112:115], v246, s[28:31], s54 offen offset:0 sc1
  ds_read_b64_tr_b16 v[214:215], v231 offset:46656
  v_mfma_f32_16x16x32_bf16 v[164:167], v[232:235], v[44:47], v[164:167]
  ds_read_b64_tr_b16 v[224:225], v231 offset:43104
  v_mfma_f32_16x16x32_bf16 v[168:171], v[232:235], v[48:51], v[168:171]
  ds_read_b64_tr_b16 v[226:227], v231 offset:46688
  v_mfma_f32_16x16x32_bf16 v[172:175], v[236:239], v[44:47], v[172:175]
  ds_read_b64_tr_b16 v[232:233], v231 offset:43136
  buffer_load_dwordx4 v[116:119], v246, s[28:31], s53 offen offset:1024 sc1
  v_mfma_f32_16x16x32_bf16 v[176:179], v[236:239], v[48:51], v[176:179]
  ds_read_b64_tr_b16 v[234:235], v231 offset:46720
  s_waitcnt lgkmcnt(6)
  v_mfma_f32_16x16x32_bf16 v[180:183], v[196:199], v[44:47], v[180:183]
  ds_read_b64_tr_b16 v[236:237], v231 offset:43168
  v_mfma_f32_16x16x32_bf16 v[184:187], v[196:199], v[48:51], v[184:187]
  ds_read_b64_tr_b16 v[238:239], v231 offset:46752
  v_mfma_f32_16x16x32_bf16 v[188:191], v[200:203], v[44:47], v[188:191]
  ds_read_b64_tr_b16 v[196:197], v231 offset:43200
  buffer_load_dwordx4 v[120:123], v246, s[28:31], s54 offen offset:1024 sc1
  v_mfma_f32_16x16x32_bf16 v[192:195], v[200:203], v[48:51], v[192:195]
  ds_read_b64_tr_b16 v[198:199], v231 offset:46784
  s_waitcnt vmcnt(14)
  v_mfma_f32_16x16x32_bf16 v[140:143], v[204:207], v[52:55], v[140:143]
  ds_read_b64_tr_b16 v[200:201], v231 offset:50176
  v_mfma_f32_16x16x32_bf16 v[144:147], v[204:207], v[56:59], v[144:147]
  ds_read_b64_tr_b16 v[202:203], v231 offset:53760
  v_mfma_f32_16x16x32_bf16 v[148:151], v[208:211], v[52:55], v[148:151]
  ds_read_b64_tr_b16 v[204:205], v231 offset:50208
  buffer_load_dwordx4 v[124:127], v246, s[28:31], s53 offen offset:2048 sc1
  v_mfma_f32_16x16x32_bf16 v[152:155], v[208:211], v[56:59], v[152:155]
  ds_read_b64_tr_b16 v[206:207], v231 offset:53792
  s_waitcnt lgkmcnt(6)
  v_mfma_f32_16x16x32_bf16 v[156:159], v[212:215], v[52:55], v[156:159]
  ds_read_b64_tr_b16 v[208:209], v231 offset:50240
  v_mfma_f32_16x16x32_bf16 v[160:163], v[212:215], v[56:59], v[160:163]
  ds_read_b64_tr_b16 v[210:211], v231 offset:53824
  v_mfma_f32_16x16x32_bf16 v[164:167], v[224:227], v[52:55], v[164:167]
  ds_read_b64_tr_b16 v[212:213], v231 offset:50272
  buffer_load_dwordx4 v[128:131], v246, s[28:31], s54 offen offset:2048 sc1
  v_mfma_f32_16x16x32_bf16 v[168:171], v[224:227], v[56:59], v[168:171]
  ds_read_b64_tr_b16 v[214:215], v231 offset:53856
  v_mfma_f32_16x16x32_bf16 v[172:175], v[232:235], v[52:55], v[172:175]
  ds_read_b64_tr_b16 v[224:225], v231 offset:50304
  v_mfma_f32_16x16x32_bf16 v[176:179], v[232:235], v[56:59], v[176:179]
  ds_read_b64_tr_b16 v[226:227], v231 offset:53888
  v_mfma_f32_16x16x32_bf16 v[180:183], v[236:239], v[52:55], v[180:183]
  ds_read_b64_tr_b16 v[232:233], v231 offset:50336
  buffer_load_dwordx4 v[132:135], v246, s[28:31], s53 offen offset:3072 sc1
  v_mfma_f32_16x16x32_bf16 v[184:187], v[236:239], v[56:59], v[184:187]
  ds_read_b64_tr_b16 v[234:235], v231 offset:53920
  s_waitcnt lgkmcnt(6)
  v_mfma_f32_16x16x32_bf16 v[188:191], v[196:199], v[52:55], v[188:191]
  ds_read_b64_tr_b16 v[236:237], v231 offset:50368
  v_mfma_f32_16x16x32_bf16 v[192:195], v[196:199], v[56:59], v[192:195]
  ds_read_b64_tr_b16 v[238:239], v231 offset:53952
  s_waitcnt vmcnt(15)
  v_mfma_f32_16x16x32_bf16 v[140:143], v[200:203], v[60:63], v[140:143]
  ds_read_b64_tr_b16 v[196:197], v230 offset:0
  buffer_load_dwordx4 v[136:139], v246, s[28:31], s54 offen offset:3072 sc1
  v_mfma_f32_16x16x32_bf16 v[144:147], v[200:203], v[64:67], v[144:147]
  ds_read_b64_tr_b16 v[198:199], v230 offset:3584
  v_mfma_f32_16x16x32_bf16 v[148:151], v[204:207], v[60:63], v[148:151]
  ds_read_b64_tr_b16 v[200:201], v230 offset:32
  v_mfma_f32_16x16x32_bf16 v[152:155], v[204:207], v[64:67], v[152:155]
  ds_read_b64_tr_b16 v[202:203], v230 offset:3616
  v_mfma_f32_16x16x32_bf16 v[156:159], v[208:211], v[60:63], v[156:159]
  s_add_u32 s59, s71, s42
  ds_read_b64_tr_b16 v[204:205], v230 offset:64
  s_add_u32 s59, s59, 262144
  v_mfma_f32_16x16x32_bf16 v[160:163], v[208:211], v[64:67], v[160:163]
  ds_read_b64_tr_b16 v[206:207], v230 offset:3648
  buffer_load_dwordx2 v[4:5], v218, s[28:31], s59 offen offset:0 sc1
  s_waitcnt lgkmcnt(6)
  v_mfma_f32_16x16x32_bf16 v[164:167], v[212:215], v[60:63], v[164:167]
  ds_read_b64_tr_b16 v[208:209], v230 offset:96
  ds_read_b64_tr_b16 v[210:211], v230 offset:3680
  v_mfma_f32_16x16x32_bf16 v[168:171], v[212:215], v[64:67], v[168:171]
  s_mov_b32 s68, 3184710632
  s_mov_b32 s69, 3222493025
  v_mfma_f32_16x16x32_bf16 v[172:175], v[224:227], v[60:63], v[172:175]
  ds_read_b64_tr_b16 v[212:213], v230 offset:128
  buffer_load_dwordx2 v[6:7], v218, s[28:31], s59 offen offset:512 sc1
  v_mfma_f32_16x16x32_bf16 v[176:179], v[224:227], v[64:67], v[176:179]
  ds_read_b64_tr_b16 v[214:215], v230 offset:3712
  v_mfma_f32_16x16x32_bf16 v[180:183], v[232:235], v[60:63], v[180:183]
  ds_read_b64_tr_b16 v[224:225], v230 offset:160
  ds_read_b64_tr_b16 v[226:227], v230 offset:3744
  v_mfma_f32_16x16x32_bf16 v[184:187], v[232:235], v[64:67], v[184:187]
  s_lshl2_add_u32 s53, s49, s3
  s_add_u32 s53, s53, 17
  v_mfma_f32_16x16x32_bf16 v[188:191], v[236:239], v[60:63], v[188:191]
  ds_read_b64_tr_b16 v[232:233], v230 offset:192
  buffer_load_dwordx2 v[8:9], v218, s[28:31], s59 offen offset:1024 sc1
  v_mfma_f32_16x16x32_bf16 v[192:195], v[236:239], v[64:67], v[192:195]
  ds_read_b64_tr_b16 v[234:235], v230 offset:3776
  s_waitcnt vmcnt(17)
  s_waitcnt lgkmcnt(6)
  v_mfma_f32_16x16x32_bf16 v[140:143], v[196:199], v[68:71], v[140:143]
  ds_read_b64_tr_b16 v[236:237], v230 offset:7168
  ds_read_b64_tr_b16 v[238:239], v230 offset:10752
  v_mfma_f32_16x16x32_bf16 v[144:147], v[196:199], v[72:75], v[144:147]
  s_lshl_b32 s53, s53, 14
  s_add_u32 s53, s53, s42
  v_mfma_f32_16x16x32_bf16 v[148:151], v[200:203], v[68:71], v[148:151]
  ds_read_b64_tr_b16 v[196:197], v230 offset:7200
  buffer_load_dwordx2 v[10:11], v218, s[28:31], s59 offen offset:1536 sc1
  v_mfma_f32_16x16x32_bf16 v[152:155], v[200:203], v[72:75], v[152:155]
  ds_read_b64_tr_b16 v[198:199], v230 offset:10784
  v_mfma_f32_16x16x32_bf16 v[156:159], v[204:207], v[68:71], v[156:159]
  ds_read_b64_tr_b16 v[200:201], v230 offset:7232
  ds_read_b64_tr_b16 v[202:203], v230 offset:10816
  v_mfma_f32_16x16x32_bf16 v[160:163], v[204:207], v[72:75], v[160:163]
  s_add_u32 s54, s53, 4096
  s_mul_i32 s9, s3, 28672
  v_mfma_f32_16x16x32_bf16 v[164:167], v[208:211], v[68:71], v[164:167]
  ds_read_b64_tr_b16 v[204:205], v230 offset:7264
  ds_read_b64_tr_b16 v[206:207], v230 offset:10848
  v_mfma_f32_16x16x32_bf16 v[168:171], v[208:211], v[72:75], v[168:171]
  s_add_u32 s9, s9, 0
  s_and_b32 s52, s4, 1
  s_waitcnt lgkmcnt(6)
  v_mfma_f32_16x16x32_bf16 v[172:175], v[212:215], v[68:71], v[172:175]
  s_add_u32 m0, s15, 8192
  ds_read_b64_tr_b16 v[208:209], v230 offset:7296
  s_add_u32 s58, s63, 0
  v_mfma_f32_16x16x32_bf16 v[176:179], v[212:215], v[72:75], v[176:179]
  ds_read_b64_tr_b16 v[210:211], v230 offset:10880
  buffer_load_dwordx4 v243, s[24:27], s58 offen offset:0 lds
  v_mfma_f32_16x16x32_bf16 v[180:183], v[224:227], v[68:71], v[180:183]
  ds_read_b64_tr_b16 v[212:213], v230 offset:7328
  ds_read_b64_tr_b16 v[214:215], v230 offset:10912
  v_mfma_f32_16x16x32_bf16 v[184:187], v[224:227], v[72:75], v[184:187]
  s_lshl3_add_u32 s51, s3, s52
  s_lshl_b32 s51, s51, 15
  v_mfma_f32_16x16x32_bf16 v[188:191], v[232:235], v[68:71], v[188:191]
  ds_read_b64_tr_b16 v[224:225], v230 offset:7360
  ds_read_b64_tr_b16 v[226:227], v230 offset:10944
  v_mfma_f32_16x16x32_bf16 v[192:195], v[232:235], v[72:75], v[192:195]
  s_add_u32 s51, s51, 278528
  s_add_u32 s51, s51, s42
  s_waitcnt vmcnt(17)
  v_mfma_f32_16x16x32_bf16 v[140:143], v[236:239], v[76:79], v[140:143]
  ds_read_b64_tr_b16 v[232:233], v230 offset:14336
  buffer_load_dwordx4 v242, s[24:27], s58 offen offset:1024 lds
  v_mfma_f32_16x16x32_bf16 v[144:147], v[236:239], v[80:83], v[144:147]
  ds_read_b64_tr_b16 v[234:235], v230 offset:17920
  s_waitcnt lgkmcnt(6)
  v_mfma_f32_16x16x32_bf16 v[148:151], v[196:199], v[76:79], v[148:151]
  ds_read_b64_tr_b16 v[236:237], v230 offset:14368
  ds_read_b64_tr_b16 v[238:239], v230 offset:17952
  v_mfma_f32_16x16x32_bf16 v[152:155], v[196:199], v[80:83], v[152:155]
  s_lshl_b32 s43, s43, 16
  s_add_u32 s43, s43, s51
  v_mfma_f32_16x16x32_bf16 v[156:159], v[200:203], v[76:79], v[156:159]
  ds_read_b64_tr_b16 v[196:197], v230 offset:14400
  ds_read_b64_tr_b16 v[198:199], v230 offset:17984
  v_mfma_f32_16x16x32_bf16 v[160:163], v[200:203], v[80:83], v[160:163]
  s_lshl_b32 s44, s44, 16
  s_add_u32 s44, s44, s51
  v_mfma_f32_16x16x32_bf16 v[164:167], v[204:207], v[76:79], v[164:167]
  ds_read_b64_tr_b16 v[200:201], v230 offset:14432
  buffer_load_dwordx4 v241, s[24:27], s58 offen offset:2048 lds
  v_mfma_f32_16x16x32_bf16 v[168:171], v[204:207], v[80:83], v[168:171]
  ds_read_b64_tr_b16 v[202:203], v230 offset:18016
  v_mfma_f32_16x16x32_bf16 v[172:175], v[208:211], v[76:79], v[172:175]
  ds_read_b64_tr_b16 v[204:205], v230 offset:14464
  ds_read_b64_tr_b16 v[206:207], v230 offset:18048
  v_mfma_f32_16x16x32_bf16 v[176:179], v[208:211], v[80:83], v[176:179]
  s_lshl_b32 s45, s45, 16
  s_add_u32 s45, s45, s51
  s_waitcnt lgkmcnt(6)
  v_mfma_f32_16x16x32_bf16 v[180:183], v[212:215], v[76:79], v[180:183]
  ds_read_b64_tr_b16 v[208:209], v230 offset:14496
  ds_read_b64_tr_b16 v[210:211], v230 offset:18080
  v_mfma_f32_16x16x32_bf16 v[184:187], v[212:215], v[80:83], v[184:187]
  s_lshl_b32 s46, s46, 16
  s_add_u32 s46, s46, s51
  v_mfma_f32_16x16x32_bf16 v[188:191], v[224:227], v[76:79], v[188:191]
  ds_read_b64_tr_b16 v[212:213], v230 offset:14528
  buffer_load_dwordx4 v240, s[24:27], s58 offen offset:3072 lds
  v_mfma_f32_16x16x32_bf16 v[192:195], v[224:227], v[80:83], v[192:195]
  ds_read_b64_tr_b16 v[214:215], v230 offset:18112
  ds_read_b64_tr_b16 a[32:33], v229 offset:0
  ds_read_b64_tr_b16 a[34:35], v229 offset:2048
  ds_read_b64_tr_b16 a[36:37], v221 offset:0
  ds_read_b64_tr_b16 a[38:39], v221 offset:2048
  ds_read_b64_tr_b16 a[40:41], v220 offset:0
  ds_read_b64_tr_b16 a[42:43], v220 offset:2048
  ds_read_b64_tr_b16 a[44:45], v219 offset:0
  ds_read_b64_tr_b16 a[46:47], v219 offset:2048
  ds_read_b64_tr_b16 a[48:49], v229 offset:4096
  ds_read_b64_tr_b16 a[50:51], v229 offset:6144
  ds_read_b64_tr_b16 a[52:53], v221 offset:4096
  ds_read_b64_tr_b16 a[54:55], v221 offset:6144
  ds_read_b64_tr_b16 a[56:57], v220 offset:4096
  ds_read_b64_tr_b16 a[58:59], v220 offset:6144
  ds_read_b64_tr_b16 a[60:61], v219 offset:4096
  ds_read_b64_tr_b16 a[62:63], v219 offset:6144
  s_waitcnt lgkmcnt(0)
  s_waitcnt vmcnt(18)
  v_mfma_f32_16x16x32_bf16 v[140:143], v[232:235], v[84:87], v[140:143]
  ds_read_b64_tr_b16 v[224:225], v230 offset:21504
  ds_read_b64_tr_b16 v[226:227], v230 offset:25088
  v_mfma_f32_16x16x32_bf16 v[144:147], v[232:235], v[96:99], v[144:147]
  s_lshr_b32 s51, s3, 1
  s_lshl_b32 s18, s51, 14
  v_mfma_f32_16x16x32_bf16 v[148:151], v[236:239], v[84:87], v[148:151]
  ds_read_b64_tr_b16 v[232:233], v230 offset:21536
  ds_read_b64_tr_b16 v[234:235], v230 offset:25120
  v_mfma_f32_16x16x32_bf16 v[152:155], v[236:239], v[96:99], v[152:155]
  s_xor_b32 s19, s18, 16384
  s_and_b32 s51, s3, 1
  v_mfma_f32_16x16x32_bf16 v[156:159], v[196:199], v[84:87], v[156:159]
  s_add_u32 m0, s15, 0
  ds_read_b64_tr_b16 v[236:237], v230 offset:21568
  s_add_u32 s58, s63, 32768
  v_mfma_f32_16x16x32_bf16 v[160:163], v[196:199], v[96:99], v[160:163]
  ds_read_b64_tr_b16 v[238:239], v230 offset:25152
  buffer_load_dwordx4 v243, s[24:27], s58 offen offset:0 lds
  v_mfma_f32_16x16x32_bf16 v[164:167], v[200:203], v[84:87], v[164:167]
  ds_read_b64_tr_b16 v[196:197], v230 offset:21600
  ds_read_b64_tr_b16 v[198:199], v230 offset:25184
  v_mfma_f32_16x16x32_bf16 v[168:171], v[200:203], v[96:99], v[168:171]
  s_lshl_b32 s52, s51, 10
  s_add_u32 s10, s18, s52
  v_mfma_f32_16x16x32_bf16 v[172:175], v[204:207], v[84:87], v[172:175]
  ds_read_b64_tr_b16 v[200:201], v230 offset:21632
  ds_read_b64_tr_b16 v[202:203], v230 offset:25216
  v_mfma_f32_16x16x32_bf16 v[176:179], v[204:207], v[96:99], v[176:179]
  s_add_u32 s16, s19, s52
  s_xor_b32 s52, s52, 1024
  v_mfma_f32_16x16x32_bf16 v[180:183], v[208:211], v[84:87], v[180:183]
  ds_read_b64_tr_b16 v[204:205], v230 offset:21664
  buffer_load_dwordx4 v242, s[24:27], s58 offen offset:1024 lds
  v_mfma_f32_16x16x32_bf16 v[184:187], v[208:211], v[96:99], v[184:187]
  ds_read_b64_tr_b16 v[206:207], v230 offset:25248
  s_waitcnt lgkmcnt(6)
  v_mfma_f32_16x16x32_bf16 v[188:191], v[212:215], v[84:87], v[188:191]
  ds_read_b64_tr_b16 v[208:209], v230 offset:21696
  ds_read_b64_tr_b16 v[210:211], v230 offset:25280
  v_mfma_f32_16x16x32_bf16 v[192:195], v[212:215], v[96:99], v[192:195]
  s_add_u32 s11, s18, s52
  s_add_u32 s17, s19, s52
  s_waitcnt vmcnt(18)
  v_mfma_f32_16x16x32_bf16 v[140:143], v[224:227], v[100:103], v[140:143]
  ds_read_b64_tr_b16 v[212:213], v230 offset:28672
  ds_read_b64_tr_b16 v[214:215], v230 offset:32256
  v_mfma_f32_16x16x32_bf16 v[144:147], v[224:227], v[104:107], v[144:147]
  s_cmp_eq_u32 s51, 0
  s_cselect_b64 s[66:67], -1, 0
  s_cmp_eq_u32 s51, 0
  s_cselect_b64 s[72:73], 0, -1
  v_mfma_f32_16x16x32_bf16 v[148:151], v[232:235], v[100:103], v[148:151]
  ds_read_b64_tr_b16 v[224:225], v230 offset:28704
  buffer_load_dwordx4 v241, s[24:27], s58 offen offset:2048 lds
  v_mfma_f32_16x16x32_bf16 v[152:155], v[232:235], v[104:107], v[152:155]
  ds_read_b64_tr_b16 v[226:227], v230 offset:32288
  v_mfma_f32_16x16x32_bf16 v[156:159], v[236:239], v[100:103], v[156:159]
  ds_read_b64_tr_b16 v[232:233], v230 offset:28736
  ds_read_b64_tr_b16 v[234:235], v230 offset:32320
  v_mfma_f32_16x16x32_bf16 v[160:163], v[236:239], v[104:107], v[160:163]
  s_cmp_eq_u32 s51, 0
  s_cselect_b32 s37, s43, s44
  s_cselect_b32 s38, s44, s43
  s_cmp_eq_u32 s51, 0
  s_cselect_b32 s39, s45, s46
  s_cselect_b32 s40, s46, s45
  s_waitcnt lgkmcnt(6)
  v_mfma_f32_16x16x32_bf16 v[164:167], v[196:199], v[100:103], v[164:167]
  ds_read_b64_tr_b16 v[236:237], v230 offset:28768
  ds_read_b64_tr_b16 v[238:239], v230 offset:32352
  v_mfma_f32_16x16x32_bf16 v[168:171], v[196:199], v[104:107], v[168:171]
  v_add_u32 v32, 4096, v246
  v_add_u32 v33, s15, v246
  v_mfma_f32_16x16x32_bf16 v[172:175], v[200:203], v[100:103], v[172:175]
  ds_read_b64_tr_b16 v[196:197], v230 offset:28800
  buffer_load_dwordx4 v240, s[24:27], s58 offen offset:3072 lds
  v_mfma_f32_16x16x32_bf16 v[176:179], v[200:203], v[104:107], v[176:179]
  ds_read_b64_tr_b16 v[198:199], v230 offset:32384
  v_mfma_f32_16x16x32_bf16 v[180:183], v[204:207], v[100:103], v[180:183]
  ds_read_b64_tr_b16 v[200:201], v230 offset:28832
  ds_read_b64_tr_b16 v[202:203], v230 offset:32416
  v_mfma_f32_16x16x32_bf16 v[184:187], v[204:207], v[104:107], v[184:187]
  s_sub_u32 s51, s9, s15
  v_add_u32 v28, s51, v229
  v_mfma_f32_16x16x32_bf16 v[188:191], v[208:211], v[100:103], v[188:191]
  ds_read_b64_tr_b16 v[204:205], v230 offset:28864
  ds_read_b64_tr_b16 v[206:207], v230 offset:32448
  v_mfma_f32_16x16x32_bf16 v[192:195], v[208:211], v[104:107], v[192:195]
  v_add_u32 v29, s51, v221
  v_add_u32 v30, s51, v220
  s_waitcnt vmcnt(18)
  s_waitcnt lgkmcnt(6)
  v_mfma_f32_16x16x32_bf16 v[140:143], v[212:215], v[108:111], v[140:143]
  s_add_u32 m0, s15, 4096
  ds_read_b64_tr_b16 v[208:209], v230 offset:35840
  s_add_u32 s58, s64, 0
  v_mfma_f32_16x16x32_bf16 v[144:147], v[212:215], v[112:115], v[144:147]
  ds_read_b64_tr_b16 v[210:211], v230 offset:39424
  buffer_load_dwordx4 v243, s[24:27], s58 offen offset:0 lds
  v_mfma_f32_16x16x32_bf16 v[148:151], v[224:227], v[108:111], v[148:151]
  ds_read_b64_tr_b16 v[212:213], v230 offset:35872
  ds_read_b64_tr_b16 v[214:215], v230 offset:39456
  v_mfma_f32_16x16x32_bf16 v[152:155], v[224:227], v[112:115], v[152:155]
  v_add_u32_e64 v31, s51, v219
  s_xor_b32 s51, s3, 1
  v_mfma_f32_16x16x32_bf16 v[156:159], v[232:235], v[108:111], v[156:159]
  ds_read_b64_tr_b16 v[224:225], v230 offset:35904
  ds_read_b64_tr_b16 v[226:227], v230 offset:39488
  v_mfma_f32_16x16x32_bf16 v[160:163], v[232:235], v[112:115], v[160:163]
  s_mul_i32 s51, s51, 12288
  s_add_u32 s51, s51, 114688
  v_mfma_f32_16x16x32_bf16 v[164:167], v[236:239], v[108:111], v[164:167]
  ds_read_b64_tr_b16 v[232:233], v230 offset:35936
  buffer_load_dwordx4 v242, s[24:27], s58 offen offset:1024 lds
  v_mfma_f32_16x16x32_bf16 v[168:171], v[236:239], v[112:115], v[168:171]
  ds_read_b64_tr_b16 v[234:235], v230 offset:39520
  s_waitcnt lgkmcnt(6)
  v_mfma_f32_16x16x32_bf16 v[172:175], v[196:199], v[108:111], v[172:175]
  ds_read_b64_tr_b16 v[236:237], v230 offset:35968
  ds_read_b64_tr_b16 v[238:239], v230 offset:39552
  v_mfma_f32_16x16x32_bf16 v[176:179], v[196:199], v[112:115], v[176:179]
  v_add_u32_e64 v45, s51, v246
  s_xor_b32 s51, s3, 2
  v_mfma_f32_16x16x32_bf16 v[180:183], v[200:203], v[108:111], v[180:183]
  ds_read_b64_tr_b16 v[196:197], v230 offset:36000
  ds_read_b64_tr_b16 v[198:199], v230 offset:39584
  v_mfma_f32_16x16x32_bf16 v[184:187], v[200:203], v[112:115], v[184:187]
  s_mul_i32 s51, s51, 12288
  s_add_u32 s51, s51, 118784
  v_mfma_f32_16x16x32_bf16 v[188:191], v[204:207], v[108:111], v[188:191]
  ds_read_b64_tr_b16 v[200:201], v230 offset:36032
  buffer_load_dwordx4 v241, s[24:27], s58 offen offset:2048 lds
  v_mfma_f32_16x16x32_bf16 v[192:195], v[204:207], v[112:115], v[192:195]
  ds_read_b64_tr_b16 v[202:203], v230 offset:39616
  s_waitcnt vmcnt(19)
  v_mfma_f32_16x16x32_bf16 v[140:143], v[208:211], v[116:119], v[140:143]
  ds_read_b64_tr_b16 v[204:205], v230 offset:43008
  ds_read_b64_tr_b16 v[206:207], v230 offset:46592
  v_mfma_f32_16x16x32_bf16 v[144:147], v[208:211], v[120:123], v[144:147]
  v_add_u32 v46, s51, v246
  s_xor_b32 s51, s3, 3
  s_waitcnt lgkmcnt(6)
  v_mfma_f32_16x16x32_bf16 v[148:151], v[212:215], v[116:119], v[148:151]
  ds_read_b64_tr_b16 v[208:209], v230 offset:43040
  ds_read_b64_tr_b16 v[210:211], v230 offset:46624
  v_mfma_f32_16x16x32_bf16 v[152:155], v[212:215], v[120:123], v[152:155]
  s_mul_i32 s51, s51, 12288
  s_add_u32 s51, s51, 122880
  v_mfma_f32_16x16x32_bf16 v[156:159], v[224:227], v[116:119], v[156:159]
  ds_read_b64_tr_b16 v[212:213], v230 offset:43072
  buffer_load_dwordx4 v240, s[24:27], s58 offen offset:3072 lds
  v_mfma_f32_16x16x32_bf16 v[160:163], v[224:227], v[120:123], v[160:163]
  ds_read_b64_tr_b16 v[214:215], v230 offset:46656
  v_mfma_f32_16x16x32_bf16 v[164:167], v[232:235], v[116:119], v[164:167]
  ds_read_b64_tr_b16 v[224:225], v230 offset:43104
  ds_read_b64_tr_b16 v[226:227], v230 offset:46688
  v_mfma_f32_16x16x32_bf16 v[168:171], v[232:235], v[120:123], v[168:171]
  v_add_u32 v47, s51, v246
  s_lshl_b32 s51, s3, 12
  v_mfma_f32_16x16x32_bf16 v[172:175], v[236:239], v[116:119], v[172:175]
  ds_read_b64_tr_b16 v[232:233], v230 offset:43136
  ds_read_b64_tr_b16 v[234:235], v230 offset:46720
  v_mfma_f32_16x16x32_bf16 v[176:179], v[236:239], v[120:123], v[176:179]
  v_mul_u32_u24 v255, 144, v249
  v_lshl_add_u32 v255, v248, 3, v255
  s_waitcnt lgkmcnt(6)
  v_mfma_f32_16x16x32_bf16 v[180:183], v[196:199], v[116:119], v[180:183]
  ds_read_b64_tr_b16 v[236:237], v230 offset:43168
  ds_read_b64_tr_b16 v[238:239], v230 offset:46752
  v_mfma_f32_16x16x32_bf16 v[184:187], v[196:199], v[120:123], v[184:187]
  v_add_u32 v34, s51, v255
  v_mul_u32_u24 v254, 144, v247
  v_mfma_f32_16x16x32_bf16 v[188:191], v[200:203], v[116:119], v[188:191]
  ds_read_b64_tr_b16 v[196:197], v230 offset:43200
  ds_read_b64_tr_b16 v[198:199], v230 offset:46784
  v_mfma_f32_16x16x32_bf16 v[192:195], v[200:203], v[120:123], v[192:195]
  v_and_b32 v253, 7, v0
  v_lshlrev_b32_e64 v253, 4, v253
  s_waitcnt vmcnt(18)
  v_mfma_f32_16x16x32_bf16 v[140:143], v[204:207], v[124:127], v[140:143]
  ds_read_b64_tr_b16 v[200:201], v230 offset:50176
  ds_read_b64_tr_b16 v[202:203], v230 offset:53760
  v_mfma_f32_16x16x32_bf16 v[144:147], v[204:207], v[128:131], v[144:147]
  s_waitcnt vmcnt(12)
  v_add_f32 v4, v4, v6
  v_mfma_f32_16x16x32_bf16 v[148:151], v[208:211], v[124:127], v[148:151]
  ds_read_b64_tr_b16 v[204:205], v230 offset:50208
  ds_read_b64_tr_b16 v[206:207], v230 offset:53792
  v_mfma_f32_16x16x32_bf16 v[152:155], v[208:211], v[128:131], v[152:155]
  v_add_f32 v8, v8, v10
  v_add_f32_e64 v5, v5, v7
  s_waitcnt lgkmcnt(6)
  v_mfma_f32_16x16x32_bf16 v[156:159], v[212:215], v[124:127], v[156:159]
  ds_read_b64_tr_b16 v[208:209], v230 offset:50240
  ds_read_b64_tr_b16 v[210:211], v230 offset:53824
  v_mfma_f32_16x16x32_bf16 v[160:163], v[212:215], v[128:131], v[160:163]
  v_add_f32 v9, v9, v11
  v_permlane32_swap_b32 v4, v5
  v_mfma_f32_16x16x32_bf16 v[164:167], v[224:227], v[124:127], v[164:167]
  ds_read_b64_tr_b16 v[212:213], v230 offset:50272
  ds_read_b64_tr_b16 v[214:215], v230 offset:53856
  v_mfma_f32_16x16x32_bf16 v[168:171], v[224:227], v[128:131], v[168:171]
  v_permlane32_swap_b32 v8, v9
  v_add_f32 v4, v4, v5
  v_mfma_f32_16x16x32_bf16 v[172:175], v[232:235], v[124:127], v[172:175]
  ds_read_b64_tr_b16 v[224:225], v230 offset:50304
  ds_read_b64_tr_b16 v[226:227], v230 offset:53888
  v_mfma_f32_16x16x32_bf16 v[176:179], v[232:235], v[128:131], v[176:179]
  v_add_f32 v8, v8, v9
  v_mov_b32 v5, v4
  v_mfma_f32_16x16x32_bf16 v[180:183], v[236:239], v[124:127], v[180:183]
  ds_read_b64_tr_b16 v[232:233], v230 offset:50336
  ds_read_b64_tr_b16 v[234:235], v230 offset:53920
  v_mfma_f32_16x16x32_bf16 v[184:187], v[236:239], v[128:131], v[184:187]
  v_mov_b32_e64 v9, v8
  v_permlane16_swap_b32 v4, v5
  s_waitcnt lgkmcnt(6)
  v_mfma_f32_16x16x32_bf16 v[188:191], v[196:199], v[124:127], v[188:191]
  ds_read_b64_tr_b16 v[236:237], v230 offset:50368
  ds_read_b64_tr_b16 v[238:239], v230 offset:53952
  v_mfma_f32_16x16x32_bf16 v[192:195], v[196:199], v[128:131], v[192:195]
  v_permlane16_swap_b32 v8, v9
  v_add_f32 v4, v4, v5
  v_mfma_f32_16x16x32_bf16 v[140:143], v[200:203], v[132:135], v[140:143]
  v_add_f32_e64 v8, v8, v9
  v_mul_f32 v4, 989855744, v4
  v_mfma_f32_16x16x32_bf16 v[144:147], v[200:203], v[136:139], v[144:147]
  v_mul_f32 v8, 989855744, v8
  v_mov_b32_e64 v5, v4
  v_mfma_f32_16x16x32_bf16 v[148:151], v[204:207], v[132:135], v[148:151]
  v_mov_b32 v9, v8
  v_permlane32_swap_b32 v4, v5
  v_mfma_f32_16x16x32_bf16 v[152:155], v[204:207], v[136:139], v[152:155]
  v_permlane32_swap_b32 v8, v9
  v_fma_f32 v5, -v4, v4, v5
  v_mfma_f32_16x16x32_bf16 v[156:159], v[208:211], v[132:135], v[156:159]
  v_fma_f32 v9, -v8, v8, v9
  v_max_f32 v5, 0, v5
  v_mfma_f32_16x16x32_bf16 v[160:163], v[208:211], v[136:139], v[160:163]
  v_max_f32_e64 v9, 0, v9
  v_add_f32 v5, 925353388, v5
  s_waitcnt lgkmcnt(0)
  v_mfma_f32_16x16x32_bf16 v[164:167], v[212:215], v[132:135], v[164:167]
  v_add_f32 v9, 925353388, v9
  v_rsq_f32 v12, v5
  v_mfma_f32_16x16x32_bf16 v[168:171], v[212:215], v[136:139], v[168:171]
  v_rsq_f32_e64 v14, v9
  v_mul_f32 v13, -v4, v12
  v_mfma_f32_16x16x32_bf16 v[172:175], v[224:227], v[132:135], v[172:175]
  v_mul_f32 v15, -v8, v14
  v_mfma_f32_16x16x32_bf16 v[176:179], v[224:227], v[136:139], v[176:179]
  v_mfma_f32_16x16x32_bf16 v[180:183], v[232:235], v[132:135], v[180:183]
  v_add3_u32 v35, v254, v253, s51
  v_mfma_f32_16x16x32_bf16 v[184:187], v[232:235], v[136:139], v[184:187]
  v_lshl_or_b32 v44, v247, 10, v253
  v_mfma_f32_16x16x32_bf16 v[188:191], v[236:239], v[132:135], v[188:191]
  v_mfma_f32_16x16x32_bf16 v[192:195], v[236:239], v[136:139], v[192:195]
  s_barrier
  s_nop 0
  s_nop 0
  s_nop 0
  v_mov_b32_dpp v20, v88 row_newbcast:0 row_mask:0xf bank_mask:0xf
  s_add_u32 m0, s9, 0
  s_add_u32 s58, s64, 32768
  buffer_load_dwordx4 v243, s[24:27], s58 offen offset:0 lds
  s_nop 0
  v_mov_b32_dpp v24, v92 row_newbcast:0 row_mask:0xf bank_mask:0xf
  v_mov_b32_dpp v21, v89 row_newbcast:0 row_mask:0xf bank_mask:0xf
  v_mov_b32_dpp v25, v93 row_newbcast:0 row_mask:0xf bank_mask:0xf
  v_mov_b32_dpp v22, v90 row_newbcast:0 row_mask:0xf bank_mask:0xf
  v_mov_b32_dpp v26, v94 row_newbcast:0 row_mask:0xf bank_mask:0xf
  v_mov_b32_dpp v23, v91 row_newbcast:0 row_mask:0xf bank_mask:0xf
  v_mov_b32_dpp v27, v95 row_newbcast:0 row_mask:0xf bank_mask:0xf
  v_pk_fma_f32 v[52:53], v[20:21], v[12:13], v[24:25] op_sel:[0,1,0] op_sel_hi:[1,1,1]
  v_pk_fma_f32 v[54:55], v[22:23], v[12:13], v[26:27] op_sel:[0,1,0] op_sel_hi:[1,1,1]
  v_pk_fma_f32 v[60:61], v[20:21], v[14:15], v[24:25] op_sel:[0,1,0] op_sel_hi:[1,1,1]
  v_pk_fma_f32 v[62:63], v[22:23], v[14:15], v[26:27] op_sel:[0,1,0] op_sel_hi:[1,1,1]
  v_pk_fma_f32 v[140:141], v[140:141], v[12:13], v[52:53] op_sel:[0,0,0] op_sel_hi:[1,0,1]
  v_pk_fma_f32 v[142:143], v[142:143], v[12:13], v[54:55] op_sel:[0,0,0] op_sel_hi:[1,0,1]
  v_pk_fma_f32 v[144:145], v[144:145], v[14:15], v[60:61] op_sel:[0,0,0] op_sel_hi:[1,0,1]
  v_pk_fma_f32 v[146:147], v[146:147], v[14:15], v[62:63] op_sel:[0,0,0] op_sel_hi:[1,0,1]
  buffer_load_dwordx4 v242, s[24:27], s58 offen offset:1024 lds
  v_pk_mul_f32 v[52:53], v[140:141], v[140:141]
  v_pk_mul_f32 v[54:55], v[142:143], v[142:143]
  v_pk_mul_f32 v[60:61], v[144:145], v[144:145]
  v_pk_mul_f32 v[62:63], v[146:147], v[146:147]
  v_pk_fma_f32 v[52:53], v[52:53], s[68:69], s[68:69] op_sel:[0,0,1] op_sel_hi:[1,0,1]
  v_pk_fma_f32 v[54:55], v[54:55], s[68:69], s[68:69] op_sel:[0,0,1] op_sel_hi:[1,0,1]
  v_pk_fma_f32 v[60:61], v[60:61], s[68:69], s[68:69] op_sel:[0,0,1] op_sel_hi:[1,0,1]
  v_pk_fma_f32 v[62:63], v[62:63], s[68:69], s[68:69] op_sel:[0,0,1] op_sel_hi:[1,0,1]
  v_pk_mul_f32 v[56:57], v[140:141], v[52:53]
  v_pk_mul_f32 v[58:59], v[142:143], v[54:55]
  v_pk_mul_f32 v[64:65], v[144:145], v[60:61]
  v_pk_mul_f32 v[66:67], v[146:147], v[62:63]
  v_exp_f32 v56, v56
  v_exp_f32 v58, v58
  buffer_load_dwordx4 v241, s[24:27], s58 offen offset:2048 lds
  v_exp_f32 v64, v64
  v_exp_f32 v66, v66
  v_exp_f32 v57, v57
  v_exp_f32 v59, v59
  v_exp_f32 v65, v65
  v_exp_f32 v67, v67
  v_pk_add_f32 v[56:57], v[56:57], 1.0 op_sel_hi:[1,0]
  v_pk_add_f32 v[58:59], v[58:59], 1.0 op_sel_hi:[1,0]
  buffer_load_dwordx4 v240, s[24:27], s58 offen offset:3072 lds
  v_pk_add_f32 v[64:65], v[64:65], 1.0 op_sel_hi:[1,0]
  v_pk_add_f32 v[66:67], v[66:67], 1.0 op_sel_hi:[1,0]
  v_rcp_f32 v56, v56
  v_rcp_f32 v58, v58
  v_rcp_f32 v64, v64
  v_rcp_f32 v66, v66
  v_rcp_f32 v57, v57
  v_rcp_f32 v59, v59
  v_rcp_f32_e64 v65, v65
  s_add_u32 m0, s9, 4096
  s_add_u32 s58, s47, 98304
  buffer_load_dwordx4 v243, s[24:27], s58 offen offset:0 lds
  v_rcp_f32_e64 v67, v67
  v_pk_mul_f32 v[140:141], v[140:141], v[56:57]
  v_pk_mul_f32 v[142:143], v[142:143], v[58:59]
  v_pk_mul_f32 v[144:145], v[144:145], v[64:65]
  v_pk_mul_f32 v[146:147], v[146:147], v[66:67]
  v_cvt_pk_bf16_f32 v68, v140, v141
  v_cvt_pk_bf16_f32 v69, v142, v143
  v_cvt_pk_bf16_f32 v72, v144, v145
  v_cvt_pk_bf16_f32 v73, v146, v147
  v_mov_b32_dpp v36, v88 row_newbcast:2 row_mask:0xf bank_mask:0xf
  v_mov_b32_dpp v40, v92 row_newbcast:2 row_mask:0xf bank_mask:0xf
  v_mov_b32_dpp v37, v89 row_newbcast:2 row_mask:0xf bank_mask:0xf
  v_mov_b32_dpp v41, v93 row_newbcast:2 row_mask:0xf bank_mask:0xf
  buffer_load_dwordx4 v242, s[24:27], s58 offen offset:1024 lds
  v_mov_b32_dpp v38, v90 row_newbcast:2 row_mask:0xf bank_mask:0xf
  v_mov_b32_dpp v42, v94 row_newbcast:2 row_mask:0xf bank_mask:0xf
  v_mov_b32_dpp v39, v91 row_newbcast:2 row_mask:0xf bank_mask:0xf
  v_mov_b32_dpp v43, v95 row_newbcast:2 row_mask:0xf bank_mask:0xf
  v_pk_fma_f32 v[52:53], v[36:37], v[12:13], v[40:41] op_sel:[0,1,0] op_sel_hi:[1,1,1]
  v_pk_fma_f32 v[54:55], v[38:39], v[12:13], v[42:43] op_sel:[0,1,0] op_sel_hi:[1,1,1]
  v_pk_fma_f32 v[60:61], v[36:37], v[14:15], v[40:41] op_sel:[0,1,0] op_sel_hi:[1,1,1]
  v_pk_fma_f32 v[62:63], v[38:39], v[14:15], v[42:43] op_sel:[0,1,0] op_sel_hi:[1,1,1]
  v_pk_fma_f32 v[148:149], v[148:149], v[12:13], v[52:53] op_sel:[0,0,0] op_sel_hi:[1,0,1]
  v_pk_fma_f32 v[150:151], v[150:151], v[12:13], v[54:55] op_sel:[0,0,0] op_sel_hi:[1,0,1]
  v_pk_fma_f32 v[152:153], v[152:153], v[14:15], v[60:61] op_sel:[0,0,0] op_sel_hi:[1,0,1]
  v_pk_fma_f32 v[154:155], v[154:155], v[14:15], v[62:63] op_sel:[0,0,0] op_sel_hi:[1,0,1]
  v_pk_mul_f32 v[52:53], v[148:149], v[148:149]
  v_pk_mul_f32 v[54:55], v[150:151], v[150:151]
  v_pk_mul_f32 v[60:61], v[152:153], v[152:153]
  s_add_u32 s58, s62, 81920
  buffer_load_dwordx4 v241, s[24:27], s58 offen offset:2048 lds
  v_pk_mul_f32 v[62:63], v[154:155], v[154:155]
  v_pk_fma_f32 v[52:53], v[52:53], s[68:69], s[68:69] op_sel:[0,0,1] op_sel_hi:[1,0,1]
  v_pk_fma_f32 v[54:55], v[54:55], s[68:69], s[68:69] op_sel:[0,0,1] op_sel_hi:[1,0,1]
  v_pk_fma_f32 v[60:61], v[60:61], s[68:69], s[68:69] op_sel:[0,0,1] op_sel_hi:[1,0,1]
  v_pk_fma_f32 v[62:63], v[62:63], s[68:69], s[68:69] op_sel:[0,0,1] op_sel_hi:[1,0,1]
  v_pk_mul_f32 v[56:57], v[148:149], v[52:53]
  v_pk_mul_f32 v[58:59], v[150:151], v[54:55]
  v_pk_mul_f32 v[64:65], v[152:153], v[60:61]
  v_pk_mul_f32 v[66:67], v[154:155], v[62:63]
  v_exp_f32 v56, v56
  v_exp_f32 v58, v58
  v_exp_f32_e64 v64, v64
  buffer_load_dwordx4 v240, s[24:27], s58 offen offset:3072 lds
  v_exp_f32 v66, v66
  v_exp_f32 v57, v57
  v_exp_f32 v59, v59
  v_exp_f32 v65, v65
  v_exp_f32_e64 v67, v67
  v_pk_add_f32 v[56:57], v[56:57], 1.0 op_sel_hi:[1,0]
  v_pk_add_f32 v[58:59], v[58:59], 1.0 op_sel_hi:[1,0]
  v_pk_add_f32 v[64:65], v[64:65], 1.0 op_sel_hi:[1,0]
  v_pk_add_f32 v[66:67], v[66:67], 1.0 op_sel_hi:[1,0]
  v_rcp_f32_e64 v56, v56
  s_add_u32 m0, s9, 8192
  s_add_u32 s58, s63, 98304
  buffer_load_dwordx4 v243, s[24:27], s58 offen offset:0 lds
  v_rcp_f32 v58, v58
  v_rcp_f32 v64, v64
  v_rcp_f32 v66, v66
  v_rcp_f32 v57, v57
  v_rcp_f32 v59, v59
  v_rcp_f32 v65, v65
  v_rcp_f32_e64 v67, v67
  buffer_load_dwordx4 v242, s[24:27], s58 offen offset:1024 lds
  v_pk_mul_f32 v[148:149], v[148:149], v[56:57]
  v_pk_mul_f32 v[150:151], v[150:151], v[58:59]
  v_pk_mul_f32 v[152:153], v[152:153], v[64:65]
  v_pk_mul_f32 v[154:155], v[154:155], v[66:67]
  v_cvt_pk_bf16_f32 v70, v148, v149
  v_cvt_pk_bf16_f32 v71, v150, v151
  v_cvt_pk_bf16_f32 v74, v152, v153
  v_cvt_pk_bf16_f32 v75, v154, v155
  buffer_store_dwordx4 v[68:71], v246, s[28:31], s53 offen offset:0 sc1
  buffer_store_dwordx4 v[72:75], v246, s[28:31], s53 offen offset:1024 sc1
  v_mov_b32_dpp v20, v88 row_newbcast:4 row_mask:0xf bank_mask:0xf
  v_mov_b32_dpp v24, v92 row_newbcast:4 row_mask:0xf bank_mask:0xf
  v_mov_b32_dpp v21, v89 row_newbcast:4 row_mask:0xf bank_mask:0xf
  v_mov_b32_dpp v25, v93 row_newbcast:4 row_mask:0xf bank_mask:0xf
  v_mov_b32_dpp v22, v90 row_newbcast:4 row_mask:0xf bank_mask:0xf
  v_mov_b32_dpp v26, v94 row_newbcast:4 row_mask:0xf bank_mask:0xf
  v_mov_b32_dpp v23, v91 row_newbcast:4 row_mask:0xf bank_mask:0xf
  s_add_u32 s58, s64, 81920
  buffer_load_dwordx4 v241, s[24:27], s58 offen offset:2048 lds
  v_mov_b32_dpp v27, v95 row_newbcast:4 row_mask:0xf bank_mask:0xf
  v_pk_fma_f32 v[52:53], v[20:21], v[12:13], v[24:25] op_sel:[0,1,0] op_sel_hi:[1,1,1]
  v_pk_fma_f32 v[54:55], v[22:23], v[12:13], v[26:27] op_sel:[0,1,0] op_sel_hi:[1,1,1]
  v_pk_fma_f32 v[60:61], v[20:21], v[14:15], v[24:25] op_sel:[0,1,0] op_sel_hi:[1,1,1]
  v_pk_fma_f32 v[62:63], v[22:23], v[14:15], v[26:27] op_sel:[0,1,0] op_sel_hi:[1,1,1]
  v_pk_fma_f32 v[156:157], v[156:157], v[12:13], v[52:53] op_sel:[0,0,0] op_sel_hi:[1,0,1]
  v_pk_fma_f32 v[158:159], v[158:159], v[12:13], v[54:55] op_sel:[0,0,0] op_sel_hi:[1,0,1]
  v_pk_fma_f32 v[160:161], v[160:161], v[14:15], v[60:61] op_sel:[0,0,0] op_sel_hi:[1,0,1]
  v_pk_fma_f32 v[162:163], v[162:163], v[14:15], v[62:63] op_sel:[0,0,0] op_sel_hi:[1,0,1]
  v_pk_mul_f32 v[52:53], v[156:157], v[156:157]
  v_pk_mul_f32 v[54:55], v[158:159], v[158:159]
  v_pk_mul_f32 v[60:61], v[160:161], v[160:161]
  v_pk_mul_f32 v[62:63], v[162:163], v[162:163]
  v_pk_fma_f32 v[52:53], v[52:53], s[68:69], s[68:69] op_sel:[0,0,1] op_sel_hi:[1,0,1]
  v_pk_fma_f32 v[54:55], v[54:55], s[68:69], s[68:69] op_sel:[0,0,1] op_sel_hi:[1,0,1]
  buffer_load_dwordx4 v240, s[24:27], s58 offen offset:3072 lds
  v_pk_fma_f32 v[60:61], v[60:61], s[68:69], s[68:69] op_sel:[0,0,1] op_sel_hi:[1,0,1]
  v_pk_fma_f32 v[62:63], v[62:63], s[68:69], s[68:69] op_sel:[0,0,1] op_sel_hi:[1,0,1]
  v_pk_mul_f32 v[56:57], v[156:157], v[52:53]
  v_pk_mul_f32 v[58:59], v[158:159], v[54:55]
  v_pk_mul_f32 v[64:65], v[160:161], v[60:61]
  v_pk_mul_f32 v[66:67], v[162:163], v[62:63]
  v_exp_f32 v56, v56
  v_exp_f32 v58, v58
  v_exp_f32 v64, v64
  v_exp_f32 v66, v66
  v_exp_f32_e64 v57, v57
  s_add_u32 m0, s9, 12288
  s_add_u32 s58, s47, 65536
  buffer_load_dwordx4 v243, s[24:27], s58 offen offset:0 lds
  v_exp_f32 v59, v59
  v_exp_f32 v65, v65
  v_exp_f32_e64 v67, v67
  v_pk_add_f32 v[56:57], v[56:57], 1.0 op_sel_hi:[1,0]
  v_pk_add_f32 v[58:59], v[58:59], 1.0 op_sel_hi:[1,0]
  v_pk_add_f32 v[64:65], v[64:65], 1.0 op_sel_hi:[1,0]
  v_pk_add_f32 v[66:67], v[66:67], 1.0 op_sel_hi:[1,0]
  v_rcp_f32 v56, v56
  v_rcp_f32 v58, v58
  buffer_load_dwordx4 v242, s[24:27], s58 offen offset:1024 lds
  v_rcp_f32 v64, v64
  v_rcp_f32 v66, v66
  v_rcp_f32 v57, v57
  v_rcp_f32 v59, v59
  v_rcp_f32 v65, v65
  v_rcp_f32 v67, v67
  v_pk_mul_f32 v[156:157], v[156:157], v[56:57]
  v_pk_mul_f32 v[158:159], v[158:159], v[58:59]
  v_pk_mul_f32 v[160:161], v[160:161], v[64:65]
  buffer_load_dwordx4 v241, s[24:27], s58 offen offset:2048 lds
  v_pk_mul_f32 v[162:163], v[162:163], v[66:67]
  v_cvt_pk_bf16_f32 v84, v156, v157
  v_cvt_pk_bf16_f32 v85, v158, v159
  v_cvt_pk_bf16_f32 v96, v160, v161
  v_cvt_pk_bf16_f32 v97, v162, v163
  s_nop 0
  s_nop 0
  v_mov_b32_dpp v36, v88 row_newbcast:6 row_mask:0xf bank_mask:0xf
  v_mov_b32_dpp v40, v92 row_newbcast:6 row_mask:0xf bank_mask:0xf
  v_mov_b32_dpp v37, v89 row_newbcast:6 row_mask:0xf bank_mask:0xf
  v_mov_b32_dpp v41, v93 row_newbcast:6 row_mask:0xf bank_mask:0xf
  v_mov_b32_dpp v38, v90 row_newbcast:6 row_mask:0xf bank_mask:0xf
  v_mov_b32_dpp v42, v94 row_newbcast:6 row_mask:0xf bank_mask:0xf
  v_mov_b32_dpp v39, v91 row_newbcast:6 row_mask:0xf bank_mask:0xf
  v_mov_b32_dpp v43, v95 row_newbcast:6 row_mask:0xf bank_mask:0xf
  v_pk_fma_f32 v[52:53], v[36:37], v[12:13], v[40:41] op_sel:[0,1,0] op_sel_hi:[1,1,1]
  v_pk_fma_f32 v[54:55], v[38:39], v[12:13], v[42:43] op_sel:[0,1,0] op_sel_hi:[1,1,1]
  buffer_load_dwordx4 v240, s[24:27], s58 offen offset:3072 lds
  v_pk_fma_f32 v[60:61], v[36:37], v[14:15], v[40:41] op_sel:[0,1,0] op_sel_hi:[1,1,1]
  v_pk_fma_f32 v[62:63], v[38:39], v[14:15], v[42:43] op_sel:[0,1,0] op_sel_hi:[1,1,1]
  v_pk_fma_f32 v[164:165], v[164:165], v[12:13], v[52:53] op_sel:[0,0,0] op_sel_hi:[1,0,1]
  v_pk_fma_f32 v[166:167], v[166:167], v[12:13], v[54:55] op_sel:[0,0,0] op_sel_hi:[1,0,1]
  v_pk_fma_f32 v[168:169], v[168:169], v[14:15], v[60:61] op_sel:[0,0,0] op_sel_hi:[1,0,1]
  v_pk_fma_f32 v[170:171], v[170:171], v[14:15], v[62:63] op_sel:[0,0,0] op_sel_hi:[1,0,1]
  v_pk_mul_f32 v[52:53], v[164:165], v[164:165]
  v_pk_mul_f32 v[54:55], v[166:167], v[166:167]
  v_pk_mul_f32 v[60:61], v[168:169], v[168:169]
  v_pk_mul_f32 v[62:63], v[170:171], v[170:171]
  v_pk_fma_f32 v[52:53], v[52:53], s[68:69], s[68:69] op_sel:[0,0,1] op_sel_hi:[1,0,1]
  v_pk_fma_f32 v[54:55], v[54:55], s[68:69], s[68:69] op_sel:[0,0,1] op_sel_hi:[1,0,1]
  v_pk_fma_f32 v[60:61], v[60:61], s[68:69], s[68:69] op_sel:[0,0,1] op_sel_hi:[1,0,1]
  v_pk_fma_f32 v[62:63], v[62:63], s[68:69], s[68:69] op_sel:[0,0,1] op_sel_hi:[1,0,1]
  v_pk_mul_f32 v[56:57], v[164:165], v[52:53]
  s_add_u32 m0, s9, 16384
  s_add_u32 s58, s62, 65536
  buffer_load_dwordx4 v243, s[24:27], s58 offen offset:0 lds
  v_pk_mul_f32 v[58:59], v[166:167], v[54:55]
  v_pk_mul_f32 v[64:65], v[168:169], v[60:61]
  v_pk_mul_f32 v[66:67], v[170:171], v[62:63]
  v_exp_f32 v56, v56
  v_exp_f32 v58, v58
  v_exp_f32 v64, v64
  v_exp_f32 v66, v66
  v_exp_f32 v57, v57
  v_exp_f32 v59, v59
  buffer_load_dwordx4 v242, s[24:27], s58 offen offset:1024 lds
  v_exp_f32 v65, v65
  v_exp_f32 v67, v67
  v_pk_add_f32 v[56:57], v[56:57], 1.0 op_sel_hi:[1,0]
  v_pk_add_f32 v[58:59], v[58:59], 1.0 op_sel_hi:[1,0]
  v_pk_add_f32 v[64:65], v[64:65], 1.0 op_sel_hi:[1,0]
  v_pk_add_f32 v[66:67], v[66:67], 1.0 op_sel_hi:[1,0]
  v_rcp_f32 v56, v56
  v_rcp_f32 v58, v58
  v_rcp_f32 v64, v64
  v_rcp_f32 v66, v66
  buffer_load_dwordx4 v241, s[24:27], s58 offen offset:2048 lds
  v_rcp_f32 v57, v57
  v_rcp_f32 v59, v59
  v_rcp_f32 v65, v65
  v_rcp_f32 v67, v67
  v_pk_mul_f32 v[164:165], v[164:165], v[56:57]
  v_pk_mul_f32 v[166:167], v[166:167], v[58:59]
  v_pk_mul_f32 v[168:169], v[168:169], v[64:65]
  v_pk_mul_f32 v[170:171], v[170:171], v[66:67]
  v_cvt_pk_bf16_f32 v86, v164, v165
  v_cvt_pk_bf16_f32 v87, v166, v167
  buffer_load_dwordx4 v240, s[24:27], s58 offen offset:3072 lds
  v_cvt_pk_bf16_f32 v98, v168, v169
  v_cvt_pk_bf16_f32 v99, v170, v171
  buffer_store_dwordx4 v[84:87], v246, s[28:31], s53 offen offset:2048 sc1
  buffer_store_dwordx4 v[96:99], v246, s[28:31], s53 offen offset:3072 sc1
  s_nop 0
  s_nop 0
  v_mov_b32_dpp v20, v88 row_newbcast:8 row_mask:0xf bank_mask:0xf
  v_mov_b32_dpp v24, v92 row_newbcast:8 row_mask:0xf bank_mask:0xf
  v_mov_b32_dpp v21, v89 row_newbcast:8 row_mask:0xf bank_mask:0xf
  v_mov_b32_dpp v25, v93 row_newbcast:8 row_mask:0xf bank_mask:0xf
  v_mov_b32_dpp v22, v90 row_newbcast:8 row_mask:0xf bank_mask:0xf
  v_mov_b32_dpp v26, v94 row_newbcast:8 row_mask:0xf bank_mask:0xf
  v_mov_b32_dpp v23, v91 row_newbcast:8 row_mask:0xf bank_mask:0xf
  v_mov_b32_dpp v27, v95 row_newbcast:8 row_mask:0xf bank_mask:0xf
  v_pk_fma_f32 v[52:53], v[20:21], v[12:13], v[24:25] op_sel:[0,1,0] op_sel_hi:[1,1,1]
  v_pk_fma_f32 v[54:55], v[22:23], v[12:13], v[26:27] op_sel:[0,1,0] op_sel_hi:[1,1,1]
  v_pk_fma_f32 v[60:61], v[20:21], v[14:15], v[24:25] op_sel:[0,1,0] op_sel_hi:[1,1,1]
  v_pk_fma_f32 v[62:63], v[22:23], v[14:15], v[26:27] op_sel:[0,1,0] op_sel_hi:[1,1,1]
  v_pk_fma_f32 v[172:173], v[172:173], v[12:13], v[52:53] op_sel:[0,0,0] op_sel_hi:[1,0,1]
  s_add_u32 m0, s9, 20480
  s_add_u32 s58, s63, 65536
  buffer_load_dwordx4 v243, s[24:27], s58 offen offset:0 lds
  v_pk_fma_f32 v[174:175], v[174:175], v[12:13], v[54:55] op_sel:[0,0,0] op_sel_hi:[1,0,1]
  v_pk_fma_f32 v[176:177], v[176:177], v[14:15], v[60:61] op_sel:[0,0,0] op_sel_hi:[1,0,1]
  v_pk_fma_f32 v[178:179], v[178:179], v[14:15], v[62:63] op_sel:[0,0,0] op_sel_hi:[1,0,1]
  v_pk_mul_f32 v[52:53], v[172:173], v[172:173]
  v_pk_mul_f32 v[54:55], v[174:175], v[174:175]
  v_pk_mul_f32 v[60:61], v[176:177], v[176:177]
  v_pk_mul_f32 v[62:63], v[178:179], v[178:179]
  v_pk_fma_f32 v[52:53], v[52:53], s[68:69], s[68:69] op_sel:[0,0,1] op_sel_hi:[1,0,1]
  v_pk_fma_f32 v[54:55], v[54:55], s[68:69], s[68:69] op_sel:[0,0,1] op_sel_hi:[1,0,1]
  v_pk_fma_f32 v[60:61], v[60:61], s[68:69], s[68:69] op_sel:[0,0,1] op_sel_hi:[1,0,1]
  v_pk_fma_f32 v[62:63], v[62:63], s[68:69], s[68:69] op_sel:[0,0,1] op_sel_hi:[1,0,1]
  v_pk_mul_f32 v[56:57], v[172:173], v[52:53]
  v_pk_mul_f32 v[58:59], v[174:175], v[54:55]
  v_pk_mul_f32 v[64:65], v[176:177], v[60:61]
  v_pk_mul_f32 v[66:67], v[178:179], v[62:63]
  buffer_load_dwordx4 v242, s[24:27], s58 offen offset:1024 lds
  v_exp_f32 v56, v56
  v_exp_f32 v58, v58
  v_exp_f32 v64, v64
  v_exp_f32 v66, v66
  v_exp_f32 v57, v57
  v_exp_f32 v59, v59
  v_exp_f32 v65, v65
  v_exp_f32 v67, v67
  buffer_load_dwordx4 v241, s[24:27], s58 offen offset:2048 lds
  v_pk_add_f32 v[56:57], v[56:57], 1.0 op_sel_hi:[1,0]
  v_pk_add_f32 v[58:59], v[58:59], 1.0 op_sel_hi:[1,0]
  v_pk_add_f32 v[64:65], v[64:65], 1.0 op_sel_hi:[1,0]
  v_pk_add_f32 v[66:67], v[66:67], 1.0 op_sel_hi:[1,0]
  v_rcp_f32 v56, v56
  v_rcp_f32 v58, v58
  v_rcp_f32 v64, v64
  v_rcp_f32 v66, v66
  v_rcp_f32_e64 v57, v57
  buffer_load_dwordx4 v240, s[24:27], s58 offen offset:3072 lds
  v_rcp_f32 v59, v59
  v_rcp_f32 v65, v65
  v_rcp_f32_e64 v67, v67
  v_pk_mul_f32 v[172:173], v[172:173], v[56:57]
  v_pk_mul_f32 v[174:175], v[174:175], v[58:59]
  v_pk_mul_f32 v[176:177], v[176:177], v[64:65]
  v_pk_mul_f32 v[178:179], v[178:179], v[66:67]
  v_cvt_pk_bf16_f32 v108, v172, v173
  v_cvt_pk_bf16_f32 v109, v174, v175
  v_cvt_pk_bf16_f32 v112, v176, v177
  v_cvt_pk_bf16_f32 v113, v178, v179
  s_nop 0
  s_nop 0
  v_mov_b32_dpp v36, v88 row_newbcast:10 row_mask:0xf bank_mask:0xf
  s_add_u32 m0, s9, 24576
  s_add_u32 s58, s64, 65536
  buffer_load_dwordx4 v243, s[24:27], s58 offen offset:0 lds
  v_mov_b32_dpp v40, v92 row_newbcast:10 row_mask:0xf bank_mask:0xf
  v_mov_b32_dpp v37, v89 row_newbcast:10 row_mask:0xf bank_mask:0xf
  v_mov_b32_dpp v41, v93 row_newbcast:10 row_mask:0xf bank_mask:0xf
  v_mov_b32_dpp v38, v90 row_newbcast:10 row_mask:0xf bank_mask:0xf
  v_mov_b32_dpp v42, v94 row_newbcast:10 row_mask:0xf bank_mask:0xf
  v_mov_b32_dpp v39, v91 row_newbcast:10 row_mask:0xf bank_mask:0xf
  v_mov_b32_dpp v43, v95 row_newbcast:10 row_mask:0xf bank_mask:0xf
  v_pk_fma_f32 v[52:53], v[36:37], v[12:13], v[40:41] op_sel:[0,1,0] op_sel_hi:[1,1,1]
  v_pk_fma_f32 v[54:55], v[38:39], v[12:13], v[42:43] op_sel:[0,1,0] op_sel_hi:[1,1,1]
  v_pk_fma_f32 v[60:61], v[36:37], v[14:15], v[40:41] op_sel:[0,1,0] op_sel_hi:[1,1,1]
  v_pk_fma_f32 v[62:63], v[38:39], v[14:15], v[42:43] op_sel:[0,1,0] op_sel_hi:[1,1,1]
  v_pk_fma_f32 v[180:181], v[180:181], v[12:13], v[52:53] op_sel:[0,0,0] op_sel_hi:[1,0,1]
  v_pk_fma_f32 v[182:183], v[182:183], v[12:13], v[54:55] op_sel:[0,0,0] op_sel_hi:[1,0,1]
  v_pk_fma_f32 v[184:185], v[184:185], v[14:15], v[60:61] op_sel:[0,0,0] op_sel_hi:[1,0,1]
  v_pk_fma_f32 v[186:187], v[186:187], v[14:15], v[62:63] op_sel:[0,0,0] op_sel_hi:[1,0,1]
  buffer_load_dwordx4 v242, s[24:27], s58 offen offset:1024 lds
  v_pk_mul_f32 v[52:53], v[180:181], v[180:181]
  v_pk_mul_f32 v[54:55], v[182:183], v[182:183]
  v_pk_mul_f32 v[60:61], v[184:185], v[184:185]
  v_pk_mul_f32 v[62:63], v[186:187], v[186:187]
  v_pk_fma_f32 v[52:53], v[52:53], s[68:69], s[68:69] op_sel:[0,0,1] op_sel_hi:[1,0,1]
  v_pk_fma_f32 v[54:55], v[54:55], s[68:69], s[68:69] op_sel:[0,0,1] op_sel_hi:[1,0,1]
  v_pk_fma_f32 v[60:61], v[60:61], s[68:69], s[68:69] op_sel:[0,0,1] op_sel_hi:[1,0,1]
  v_pk_fma_f32 v[62:63], v[62:63], s[68:69], s[68:69] op_sel:[0,0,1] op_sel_hi:[1,0,1]
  v_pk_mul_f32 v[56:57], v[180:181], v[52:53]
  v_pk_mul_f32 v[58:59], v[182:183], v[54:55]
  v_pk_mul_f32 v[64:65], v[184:185], v[60:61]
  v_pk_mul_f32 v[66:67], v[186:187], v[62:63]
  v_exp_f32 v56, v56
  v_exp_f32 v58, v58
  buffer_load_dwordx4 v241, s[24:27], s58 offen offset:2048 lds
  v_exp_f32 v64, v64
  v_exp_f32 v66, v66
  v_exp_f32 v57, v57
  v_exp_f32 v59, v59
  v_exp_f32 v65, v65
  v_exp_f32 v67, v67
  v_pk_add_f32 v[56:57], v[56:57], 1.0 op_sel_hi:[1,0]
  v_pk_add_f32 v[58:59], v[58:59], 1.0 op_sel_hi:[1,0]
  buffer_load_dwordx4 v240, s[24:27], s58 offen offset:3072 lds
  v_pk_add_f32 v[64:65], v[64:65], 1.0 op_sel_hi:[1,0]
  v_pk_add_f32 v[66:67], v[66:67], 1.0 op_sel_hi:[1,0]
  v_rcp_f32 v56, v56
  v_rcp_f32 v58, v58
  v_rcp_f32 v64, v64
  v_rcp_f32 v66, v66
  v_rcp_f32 v57, v57
  v_rcp_f32 v59, v59
  v_rcp_f32 v65, v65
  v_rcp_f32 v67, v67
  v_pk_mul_f32 v[180:181], v[180:181], v[56:57]
  v_pk_mul_f32 v[182:183], v[182:183], v[58:59]
  v_pk_mul_f32 v[184:185], v[184:185], v[64:65]
  v_pk_mul_f32 v[186:187], v[186:187], v[66:67]
  v_cvt_pk_bf16_f32 v110, v180, v181
  v_cvt_pk_bf16_f32 v111, v182, v183
  v_cvt_pk_bf16_f32 v114, v184, v185
  v_cvt_pk_bf16_f32 v115, v186, v187
  v_mov_b32_dpp v20, v88 row_newbcast:12 row_mask:0xf bank_mask:0xf
  v_mov_b32_dpp v24, v92 row_newbcast:12 row_mask:0xf bank_mask:0xf
  v_mov_b32_dpp v21, v89 row_newbcast:12 row_mask:0xf bank_mask:0xf
  v_mov_b32_dpp v25, v93 row_newbcast:12 row_mask:0xf bank_mask:0xf
  v_mov_b32_dpp v22, v90 row_newbcast:12 row_mask:0xf bank_mask:0xf
  v_mov_b32_dpp v26, v94 row_newbcast:12 row_mask:0xf bank_mask:0xf
  v_mov_b32_dpp v23, v91 row_newbcast:12 row_mask:0xf bank_mask:0xf
  v_mov_b32_dpp v27, v95 row_newbcast:12 row_mask:0xf bank_mask:0xf
  v_pk_fma_f32 v[52:53], v[20:21], v[12:13], v[24:25] op_sel:[0,1,0] op_sel_hi:[1,1,1]
  v_pk_fma_f32 v[54:55], v[22:23], v[12:13], v[26:27] op_sel:[0,1,0] op_sel_hi:[1,1,1]
  v_pk_fma_f32 v[60:61], v[20:21], v[14:15], v[24:25] op_sel:[0,1,0] op_sel_hi:[1,1,1]
  v_pk_fma_f32 v[62:63], v[22:23], v[14:15], v[26:27] op_sel:[0,1,0] op_sel_hi:[1,1,1]
  v_pk_fma_f32 v[188:189], v[188:189], v[12:13], v[52:53] op_sel:[0,0,0] op_sel_hi:[1,0,1]
  v_pk_fma_f32 v[190:191], v[190:191], v[12:13], v[54:55] op_sel:[0,0,0] op_sel_hi:[1,0,1]
  v_pk_fma_f32 v[192:193], v[192:193], v[14:15], v[60:61] op_sel:[0,0,0] op_sel_hi:[1,0,1]
  v_pk_fma_f32 v[194:195], v[194:195], v[14:15], v[62:63] op_sel:[0,0,0] op_sel_hi:[1,0,1]
  v_pk_mul_f32 v[52:53], v[188:189], v[188:189]
  v_pk_mul_f32 v[54:55], v[190:191], v[190:191]
  v_pk_mul_f32 v[60:61], v[192:193], v[192:193]
  v_pk_mul_f32 v[62:63], v[194:195], v[194:195]
  v_pk_fma_f32 v[52:53], v[52:53], s[68:69], s[68:69] op_sel:[0,0,1] op_sel_hi:[1,0,1]
  v_pk_fma_f32 v[54:55], v[54:55], s[68:69], s[68:69] op_sel:[0,0,1] op_sel_hi:[1,0,1]
  v_pk_fma_f32 v[60:61], v[60:61], s[68:69], s[68:69] op_sel:[0,0,1] op_sel_hi:[1,0,1]
  v_pk_fma_f32 v[62:63], v[62:63], s[68:69], s[68:69] op_sel:[0,0,1] op_sel_hi:[1,0,1]
  v_pk_mul_f32 v[56:57], v[188:189], v[52:53]
  v_pk_mul_f32 v[58:59], v[190:191], v[54:55]
  v_pk_mul_f32 v[64:65], v[192:193], v[60:61]
  v_pk_mul_f32 v[66:67], v[194:195], v[62:63]
  v_exp_f32 v56, v56
  v_exp_f32 v58, v58
  v_exp_f32 v64, v64
  v_exp_f32 v66, v66
  v_exp_f32 v57, v57
  v_exp_f32 v59, v59
  v_exp_f32 v65, v65
  v_exp_f32 v67, v67
  v_pk_add_f32 v[56:57], v[56:57], 1.0 op_sel_hi:[1,0]
  v_pk_add_f32 v[58:59], v[58:59], 1.0 op_sel_hi:[1,0]
  v_pk_add_f32 v[64:65], v[64:65], 1.0 op_sel_hi:[1,0]
  v_pk_add_f32 v[66:67], v[66:67], 1.0 op_sel_hi:[1,0]
  v_rcp_f32 v56, v56
  v_rcp_f32 v58, v58
  v_rcp_f32 v64, v64
  v_rcp_f32 v66, v66
  v_rcp_f32 v57, v57
  v_rcp_f32 v59, v59
  v_rcp_f32 v65, v65
  v_rcp_f32 v67, v67
  v_pk_mul_f32 v[188:189], v[188:189], v[56:57]
  v_pk_mul_f32 v[190:191], v[190:191], v[58:59]
  v_pk_mul_f32 v[192:193], v[192:193], v[64:65]
  v_pk_mul_f32 v[194:195], v[194:195], v[66:67]
  v_cvt_pk_bf16_f32 v124, v188, v189
  v_cvt_pk_bf16_f32 v125, v190, v191
  v_cvt_pk_bf16_f32 v126, v192, v193
  v_cvt_pk_bf16_f32 v127, v194, v195
  s_waitcnt vmcnt(8)
  s_barrier
  s_cmp_lg_u32 s3, 0
  s_cbranch_scc1 L_fl_skip_37
  s_mov_b64 exec, 1
  s_cmp_eq_u32 s48, 0
  s_cbranch_scc1 L_fl_slow_38
  buffer_store_dword v245, v244, s[28:31], s36 offen offset:16
L_fl_skip_37:
  s_mov_b64 exec, -1
  buffer_store_dwordx4 v[108:111], v246, s[28:31], s54 offen offset:0 sc1
  buffer_store_dwordx4 v[112:115], v246, s[28:31], s54 offen offset:1024 sc1
  buffer_store_dwordx4 v[124:127], v246, s[28:31], s54 offen offset:2048 sc1
  ds_read_b64_tr_b16 a[64:65], v229 offset:8192
  ds_read_b64_tr_b16 a[66:67], v229 offset:10240
  ds_read_b64_tr_b16 a[68:69], v221 offset:8192
  ds_read_b64_tr_b16 a[70:71], v221 offset:10240
  ds_read_b64_tr_b16 a[72:73], v220 offset:8192
  ds_read_b64_tr_b16 a[74:75], v220 offset:10240
  ds_read_b64_tr_b16 a[76:77], v219 offset:8192
  ds_read_b64_tr_b16 a[78:79], v219 offset:10240
  ds_read_b64_tr_b16 a[80:81], v229 offset:0
  ds_read_b64_tr_b16 a[82:83], v229 offset:2048
  ds_read_b64_tr_b16 a[84:85], v221 offset:0
  ds_read_b64_tr_b16 a[86:87], v221 offset:2048
  ds_read_b64_tr_b16 a[88:89], v220 offset:0
  ds_read_b64_tr_b16 a[90:91], v220 offset:2048
  ds_read_b64_tr_b16 a[92:93], v219 offset:0
  ds_read_b64_tr_b16 a[94:95], v219 offset:2048
  ds_read_b64_tr_b16 a[96:97], v229 offset:4096
  ds_read_b64_tr_b16 a[98:99], v229 offset:6144
  ds_read_b64_tr_b16 a[100:101], v221 offset:4096
  ds_read_b64_tr_b16 a[102:103], v221 offset:6144
  ds_read_b64_tr_b16 a[104:105], v220 offset:4096
  ds_read_b64_tr_b16 a[106:107], v220 offset:6144
  ds_read_b64_tr_b16 a[108:109], v219 offset:4096
  ds_read_b64_tr_b16 a[110:111], v219 offset:6144
  v_accvgpr_read_b32 v238, a232
  v_accvgpr_read_b32 v239, a233
  v_accvgpr_read_b32 v255, a224
  v_accvgpr_read_b32 v254, a225
  v_mov_b32_dpp v253, v238 quad_perm:[0,0,0,0] row_mask:0xf bank_mask:0xf
  v_mov_b32_dpp v252, v239 quad_perm:[0,0,0,0] row_mask:0xf bank_mask:0xf
  v_lshlrev_b32_e64 v88, 16, v255
  v_and_b32 v89, 0xffff0000, v255
  v_lshlrev_b32_e64 v90, 16, v254
  v_and_b32 v91, 0xffff0000, v254
  v_lshlrev_b32_e64 v255, 16, v253
  v_and_b32 v254, 0xffff0000, v253
  v_lshlrev_b32_e64 v253, 16, v252
  v_and_b32 v252, 0xffff0000, v252
  v_add_f32 v88, v88, v255
  v_add_f32 v89, v89, v254
  v_add_f32 v90, v90, v253
  v_add_f32 v91, v91, v252
  v_accvgpr_read_b32 v255, a226
  v_accvgpr_read_b32 v254, a227
  v_mov_b32_dpp v253, v238 quad_perm:[1,1,1,1] row_mask:0xf bank_mask:0xf
  v_mov_b32_dpp v252, v239 quad_perm:[1,1,1,1] row_mask:0xf bank_mask:0xf
  v_lshlrev_b32_e64 v92, 16, v255
  v_and_b32 v93, 0xffff0000, v255
  v_lshlrev_b32_e64 v94, 16, v254
  v_and_b32 v95, 0xffff0000, v254
  v_lshlrev_b32_e64 v255, 16, v253
  v_and_b32 v254, 0xffff0000, v253
  v_lshlrev_b32_e64 v253, 16, v252
  v_and_b32 v252, 0xffff0000, v252
  v_add_f32 v92, v92, v255
  v_add_f32 v93, v93, v254
  v_add_f32 v94, v94, v253
  v_add_f32 v95, v95, v252
  v_accvgpr_read_b32 v255, a228
  v_accvgpr_read_b32 v254, a229
  v_mov_b32_dpp v253, v238 quad_perm:[2,2,2,2] row_mask:0xf bank_mask:0xf
  v_mov_b32_dpp v252, v239 quad_perm:[2,2,2,2] row_mask:0xf bank_mask:0xf
  v_lshlrev_b32_e64 v140, 16, v255
  v_and_b32 v141, 0xffff0000, v255
  v_lshlrev_b32_e64 v142, 16, v254
  v_and_b32 v143, 0xffff0000, v254
  v_lshlrev_b32_e64 v255, 16, v253
  v_and_b32 v254, 0xffff0000, v253
  v_lshlrev_b32_e64 v253, 16, v252
  v_and_b32 v252, 0xffff0000, v252
  v_add_f32 v140, v140, v255
  v_add_f32 v141, v141, v254
  v_add_f32 v142, v142, v253
  v_add_f32 v143, v143, v252
  v_accvgpr_read_b32 v255, a230
  v_accvgpr_read_b32 v254, a231
  v_mov_b32_dpp v253, v238 quad_perm:[3,3,3,3] row_mask:0xf bank_mask:0xf
  v_mov_b32_dpp v252, v239 quad_perm:[3,3,3,3] row_mask:0xf bank_mask:0xf
  v_lshlrev_b32_e64 v144, 16, v255
  v_and_b32 v145, 0xffff0000, v255
  v_lshlrev_b32_e64 v146, 16, v254
  v_and_b32 v147, 0xffff0000, v254
  v_lshlrev_b32_e64 v255, 16, v253
  v_and_b32 v254, 0xffff0000, v253
  v_lshlrev_b32_e64 v253, 16, v252
  v_and_b32 v252, 0xffff0000, v252
  v_add_f32 v144, v144, v255
  v_add_f32 v145, v145, v254
  v_add_f32 v146, v146, v253
  v_add_f32 v147, v147, v252
  s_mov_b64 exec, 65535
  s_mov_b32 s57, 0
  buffer_load_dword v2, v244, s[28:31], s90 offen offset:16 sc1
L_poll_39:
  buffer_load_dword v3, v244, s[28:31], s90 offen offset:16 sc1
  s_waitcnt vmcnt(1)
  v_cmp_ne_u32 vcc, s7, v2
  s_cbranch_vccz L_poll_e_40
  buffer_load_dword v2, v244, s[28:31], s90 offen offset:16 sc1
  s_waitcnt vmcnt(1)
  v_cmp_ne_u32 vcc, s7, v3
  s_cbranch_vccz L_poll_e_40
  s_add_u32 s57, s57, 1
  s_cmp_le_u32 s57, 262144
  s_cbranch_scc1 L_poll_39
L_poll_e_40:
  s_mov_b64 exec, -1
  s_waitcnt lgkmcnt(0)
  s_barrier
  s_cmp_lg_u32 s3, 0
  s_cbranch_scc1 L_fl_skip_41
  s_mov_b64 exec, 1
  s_cmp_eq_u32 s48, 0
  s_cbranch_scc1 L_fl_slow_42
  buffer_store_dword v245, v244, s[28:31], s36 offen offset:20
L_fl_skip_41:
  s_mov_b64 exec, -1
  s_add_u32 s51, s43, s16
  buffer_load_dwordx4 v[4:7], v246, s[28:31], s51 offen offset:0 sc1
  s_add_u32 s52, s43, s17
  buffer_load_dwordx4 v[8:11], v246, s[28:31], s52 offen offset:0 sc1
  s_add_u32 s51, s43, s10
  buffer_load_dwordx4 v[12:15], v246, s[28:31], s51 offen offset:0 sc1
  s_add_u32 s52, s43, s11
  buffer_load_dwordx4 v[16:19], v246, s[28:31], s52 offen offset:0 sc1
  s_add_u32 s51, s43, s16
  buffer_load_dwordx4 v[20:23], v246, s[28:31], s51 offen offset:2048 sc1
  s_add_u32 s52, s43, s17
  buffer_load_dwordx4 v[24:27], v246, s[28:31], s52 offen offset:2048 sc1
  s_add_u32 s51, s43, s10
  buffer_load_dwordx4 v[36:39], v246, s[28:31], s51 offen offset:2048 sc1
  s_add_u32 s52, s43, s11
  buffer_load_dwordx4 v[40:43], v246, s[28:31], s52 offen offset:2048 sc1
  s_add_u32 s51, s44, s16
  buffer_load_dwordx4 v[48:51], v246, s[28:31], s51 offen offset:0 sc1
  s_add_u32 s52, s44, s17
  buffer_load_dwordx4 v[52:55], v246, s[28:31], s52 offen offset:0 sc1
  s_waitcnt vmcnt(9)
  v_mfma_f32_16x16x32_bf16 v[164:167], a[0:3], v[4:7], 0
  s_add_u32 s51, s44, s10
  buffer_load_dwordx4 v[56:59], v246, s[28:31], s51 offen offset:0 sc1
  v_mfma_f32_16x16x32_bf16 v[168:171], a[4:7], v[4:7], 0
  s_add_u32 s52, s44, s11
  buffer_load_dwordx4 v[60:63], v246, s[28:31], s52 offen offset:0 sc1
  v_mfma_f32_16x16x32_bf16 v[172:175], a[8:11], v[4:7], 0
  ds_read_b64_tr_b16 a[112:113], v28 offset:0
  ds_read_b64_tr_b16 a[114:115], v28 offset:2048
  v_mfma_f32_16x16x32_bf16 v[176:179], a[12:15], v[4:7], 0
  ds_read_b64_tr_b16 a[116:117], v29 offset:0
  s_waitcnt vmcnt(10)
  v_mfma_f32_16x16x32_bf16 v[180:183], a[0:3], v[8:11], 0
  s_add_u32 s51, s44, s16
  buffer_load_dwordx4 v[64:67], v246, s[28:31], s51 offen offset:2048 sc1
  v_mfma_f32_16x16x32_bf16 v[184:187], a[4:7], v[8:11], 0
  s_add_u32 s52, s44, s17
  buffer_load_dwordx4 v[68:71], v246, s[28:31], s52 offen offset:2048 sc1
  v_mfma_f32_16x16x32_bf16 v[188:191], a[8:11], v[8:11], 0
  ds_read_b64_tr_b16 a[118:119], v29 offset:2048
  ds_read_b64_tr_b16 a[120:121], v30 offset:0
  v_mfma_f32_16x16x32_bf16 v[192:195], a[12:15], v[8:11], 0
  ds_read_b64_tr_b16 a[122:123], v30 offset:2048
  s_waitcnt vmcnt(11)
  v_mfma_f32_16x16x32_bf16 v[88:91], a[0:3], v[12:15], v[88:91]
  s_add_u32 s51, s44, s10
  buffer_load_dwordx4 v[72:75], v246, s[28:31], s51 offen offset:2048 sc1
  v_mfma_f32_16x16x32_bf16 v[92:95], a[4:7], v[12:15], v[92:95]
  ds_read_b64_tr_b16 a[124:125], v31 offset:0
  v_mfma_f32_16x16x32_bf16 v[140:143], a[8:11], v[12:15], v[140:143]
  ds_read_b64_tr_b16 a[126:127], v31 offset:2048
  v_mfma_f32_16x16x32_bf16 v[144:147], a[12:15], v[12:15], v[144:147]
  ds_read_b64_tr_b16 a[128:129], v28 offset:4096
  s_waitcnt vmcnt(11)
  v_mfma_f32_16x16x32_bf16 v[148:151], a[0:3], v[16:19], 0
  s_add_u32 s52, s44, s11
  buffer_load_dwordx4 v[76:79], v246, s[28:31], s52 offen offset:2048 sc1
  v_mfma_f32_16x16x32_bf16 v[152:155], a[4:7], v[16:19], 0
  ds_read_b64_tr_b16 a[130:131], v28 offset:6144
  v_mfma_f32_16x16x32_bf16 v[156:159], a[8:11], v[16:19], 0
  ds_read_b64_tr_b16 a[132:133], v29 offset:4096
  v_mfma_f32_16x16x32_bf16 v[160:163], a[12:15], v[16:19], 0
  ds_read_b64_tr_b16 a[134:135], v29 offset:6144
  s_waitcnt vmcnt(11)
  v_mfma_f32_16x16x32_bf16 v[164:167], a[16:19], v[20:23], v[164:167]
  s_add_u32 s51, s45, s16
  buffer_load_dwordx4 v[80:83], v246, s[28:31], s51 offen offset:0 sc1
  v_mfma_f32_16x16x32_bf16 v[168:171], a[20:23], v[20:23], v[168:171]
  ds_read_b64_tr_b16 a[136:137], v30 offset:4096
  v_mfma_f32_16x16x32_bf16 v[172:175], a[24:27], v[20:23], v[172:175]
  ds_read_b64_tr_b16 a[138:139], v30 offset:6144
  v_mfma_f32_16x16x32_bf16 v[176:179], a[28:31], v[20:23], v[176:179]
  ds_read_b64_tr_b16 a[140:141], v31 offset:4096
  s_waitcnt vmcnt(11)
  v_mfma_f32_16x16x32_bf16 v[180:183], a[16:19], v[24:27], v[180:183]
  s_add_u32 s52, s45, s17
  buffer_load_dwordx4 v[84:87], v246, s[28:31], s52 offen offset:0 sc1
  v_mfma_f32_16x16x32_bf16 v[184:187], a[20:23], v[24:27], v[184:187]
  ds_read_b64_tr_b16 a[142:143], v31 offset:6144
  v_mfma_f32_16x16x32_bf16 v[188:191], a[24:27], v[24:27], v[188:191]
  ds_read_b64_tr_b16 a[144:145], v28 offset:8192
  v_mfma_f32_16x16x32_bf16 v[192:195], a[28:31], v[24:27], v[192:195]
  ds_read_b64_tr_b16 a[146:147], v28 offset:10240
  s_waitcnt vmcnt(11)
  v_mfma_f32_16x16x32_bf16 v[88:91], a[16:19], v[36:39], v[88:91]
  s_mov_b64 exec, 0xffff
  buffer_load_dword v3, v244, s[28:31], s90 offen offset:20 sc1
  s_mov_b64 exec, -1
  s_add_u32 s51, s45, s10
  v_mfma_f32_16x16x32_bf16 v[92:95], a[20:23], v[36:39], v[92:95]
  buffer_load_dwordx4 v[96:99], v246, s[28:31], s51 offen offset:0 sc1
  ds_read_b64_tr_b16 a[148:149], v29 offset:8192
  v_mfma_f32_16x16x32_bf16 v[140:143], a[24:27], v[36:39], v[140:143]
  ds_read_b64_tr_b16 a[150:151], v29 offset:10240
  v_mfma_f32_16x16x32_bf16 v[144:147], a[28:31], v[36:39], v[144:147]
  ds_read_b64_tr_b16 a[152:153], v30 offset:8192
  s_waitcnt vmcnt(12)
  v_mfma_f32_16x16x32_bf16 v[148:151], a[16:19], v[40:43], v[148:151]
  s_add_u32 s52, s45, s11
  buffer_load_dwordx4 v[100:103], v246, s[28:31], s52 offen offset:0 sc1
  v_mfma_f32_16x16x32_bf16 v[152:155], a[20:23], v[40:43], v[152:155]
  ds_read_b64_tr_b16 a[154:155], v30 offset:10240
  v_mfma_f32_16x16x32_bf16 v[156:159], a[24:27], v[40:43], v[156:159]
  ds_read_b64_tr_b16 a[156:157], v31 offset:8192
  v_mfma_f32_16x16x32_bf16 v[160:163], a[28:31], v[40:43], v[160:163]
  ds_read_b64_tr_b16 a[158:159], v31 offset:10240
  s_waitcnt vmcnt(12)
  v_mfma_f32_16x16x32_bf16 v[164:167], a[32:35], v[48:51], v[164:167]
  s_add_u32 s51, s45, s16
  buffer_load_dwordx4 v[104:107], v246, s[28:31], s51 offen offset:2048 sc1
  v_mfma_f32_16x16x32_bf16 v[168:171], a[36:39], v[48:51], v[168:171]
  ds_read_b64_tr_b16 a[160:161], v28 offset:12288
  v_mfma_f32_16x16x32_bf16 v[172:175], a[40:43], v[48:51], v[172:175]
  ds_read_b64_tr_b16 a[162:163], v28 offset:14336
  v_mfma_f32_16x16x32_bf16 v[176:179], a[44:47], v[48:51], v[176:179]
  ds_read_b64_tr_b16 a[164:165], v29 offset:12288
  s_waitcnt vmcnt(12)
  v_mfma_f32_16x16x32_bf16 v[180:183], a[32:35], v[52:55], v[180:183]
  s_add_u32 s52, s45, s17
  buffer_load_dwordx4 v[108:111], v246, s[28:31], s52 offen offset:2048 sc1
  v_mfma_f32_16x16x32_bf16 v[184:187], a[36:39], v[52:55], v[184:187]
  ds_read_b64_tr_b16 a[166:167], v29 offset:14336
  v_mfma_f32_16x16x32_bf16 v[188:191], a[40:43], v[52:55], v[188:191]
  ds_read_b64_tr_b16 a[168:169], v30 offset:12288
  v_mfma_f32_16x16x32_bf16 v[192:195], a[44:47], v[52:55], v[192:195]
  ds_read_b64_tr_b16 a[170:171], v30 offset:14336
  s_waitcnt vmcnt(12)
  v_mfma_f32_16x16x32_bf16 v[88:91], a[32:35], v[56:59], v[88:91]
  s_add_u32 s51, s45, s10
  buffer_load_dwordx4 v[112:115], v246, s[28:31], s51 offen offset:2048 sc1
  v_mfma_f32_16x16x32_bf16 v[92:95], a[36:39], v[56:59], v[92:95]
  ds_read_b64_tr_b16 a[172:173], v31 offset:12288
  v_mfma_f32_16x16x32_bf16 v[140:143], a[40:43], v[56:59], v[140:143]
  ds_read_b64_tr_b16 a[174:175], v31 offset:14336
  v_mfma_f32_16x16x32_bf16 v[144:147], a[44:47], v[56:59], v[144:147]
  ds_read_b64_tr_b16 a[176:177], v28 offset:16384
  s_waitcnt vmcnt(12)
  v_mfma_f32_16x16x32_bf16 v[148:151], a[32:35], v[60:63], v[148:151]
  s_add_u32 s52, s45, s11
  buffer_load_dwordx4 v[116:119], v246, s[28:31], s52 offen offset:2048 sc1
  v_mfma_f32_16x16x32_bf16 v[152:155], a[36:39], v[60:63], v[152:155]
  ds_read_b64_tr_b16 a[178:179], v28 offset:18432
  v_mfma_f32_16x16x32_bf16 v[156:159], a[40:43], v[60:63], v[156:159]
  ds_read_b64_tr_b16 a[180:181], v29 offset:16384
  v_mfma_f32_16x16x32_bf16 v[160:163], a[44:47], v[60:63], v[160:163]
  ds_read_b64_tr_b16 a[182:183], v29 offset:18432
  s_waitcnt vmcnt(12)
  v_mfma_f32_16x16x32_bf16 v[164:167], a[48:51], v[64:67], v[164:167]
  s_add_u32 s51, s46, s16
  buffer_load_dwordx4 v[4:7], v246, s[28:31], s51 offen offset:0 sc1
  v_mfma_f32_16x16x32_bf16 v[168:171], a[52:55], v[64:67], v[168:171]
  ds_read_b64_tr_b16 a[184:185], v30 offset:16384
  v_mfma_f32_16x16x32_bf16 v[172:175], a[56:59], v[64:67], v[172:175]
  ds_read_b64_tr_b16 a[186:187], v30 offset:18432
  v_mfma_f32_16x16x32_bf16 v[176:179], a[60:63], v[64:67], v[176:179]
  ds_read_b64_tr_b16 a[188:189], v31 offset:16384
  s_waitcnt vmcnt(12)
  v_mfma_f32_16x16x32_bf16 v[180:183], a[48:51], v[68:71], v[180:183]
  s_add_u32 s52, s46, s17
  buffer_load_dwordx4 v[8:11], v246, s[28:31], s52 offen offset:0 sc1
  v_mfma_f32_16x16x32_bf16 v[184:187], a[52:55], v[68:71], v[184:187]
  ds_read_b64_tr_b16 a[190:191], v31 offset:18432
  v_mfma_f32_16x16x32_bf16 v[188:191], a[56:59], v[68:71], v[188:191]
  ds_read_b64_tr_b16 a[192:193], v28 offset:20480
  v_mfma_f32_16x16x32_bf16 v[192:195], a[60:63], v[68:71], v[192:195]
  ds_read_b64_tr_b16 a[194:195], v28 offset:22528
  s_waitcnt vmcnt(12)
  v_mfma_f32_16x16x32_bf16 v[88:91], a[48:51], v[72:75], v[88:91]
  s_add_u32 s51, s46, s10
  buffer_load_dwordx4 v[12:15], v246, s[28:31], s51 offen offset:0 sc1
  v_mfma_f32_16x16x32_bf16 v[92:95], a[52:55], v[72:75], v[92:95]
  ds_read_b64_tr_b16 a[196:197], v29 offset:20480
  v_mfma_f32_16x16x32_bf16 v[140:143], a[56:59], v[72:75], v[140:143]
  ds_read_b64_tr_b16 a[198:199], v29 offset:22528
  v_mfma_f32_16x16x32_bf16 v[144:147], a[60:63], v[72:75], v[144:147]
  ds_read_b64_tr_b16 a[200:201], v30 offset:20480
  s_waitcnt vmcnt(12)
  v_mfma_f32_16x16x32_bf16 v[148:151], a[48:51], v[76:79], v[148:151]
  s_add_u32 s52, s46, s11
  buffer_load_dwordx4 v[16:19], v246, s[28:31], s52 offen offset:0 sc1
  v_mfma_f32_16x16x32_bf16 v[152:155], a[52:55], v[76:79], v[152:155]
  ds_read_b64_tr_b16 a[202:203], v30 offset:22528
  v_mfma_f32_16x16x32_bf16 v[156:159], a[56:59], v[76:79], v[156:159]
  ds_read_b64_tr_b16 a[204:205], v31 offset:20480
  v_mfma_f32_16x16x32_bf16 v[160:163], a[60:63], v[76:79], v[160:163]
  ds_read_b64_tr_b16 a[206:207], v31 offset:22528
  s_waitcnt vmcnt(12)
  v_mfma_f32_16x16x32_bf16 v[164:167], a[64:67], v[80:83], v[164:167]
  s_add_u32 s51, s46, s16
  buffer_load_dwordx4 v[20:23], v246, s[28:31], s51 offen offset:2048 sc1
  v_mfma_f32_16x16x32_bf16 v[168:171], a[68:71], v[80:83], v[168:171]
  ds_read_b64_tr_b16 a[208:209], v28 offset:24576
  v_mfma_f32_16x16x32_bf16 v[172:175], a[72:75], v[80:83], v[172:175]
  ds_read_b64_tr_b16 a[210:211], v28 offset:26624
  v_mfma_f32_16x16x32_bf16 v[176:179], a[76:79], v[80:83], v[176:179]
  ds_read_b64_tr_b16 a[212:213], v29 offset:24576
  s_waitcnt vmcnt(12)
  v_mfma_f32_16x16x32_bf16 v[180:183], a[64:67], v[84:87], v[180:183]
  s_add_u32 s52, s46, s17
  buffer_load_dwordx4 v[24:27], v246, s[28:31], s52 offen offset:2048 sc1
  v_mfma_f32_16x16x32_bf16 v[184:187], a[68:71], v[84:87], v[184:187]
  ds_read_b64_tr_b16 a[214:215], v29 offset:26624
  v_mfma_f32_16x16x32_bf16 v[188:191], a[72:75], v[84:87], v[188:191]
  ds_read_b64_tr_b16 a[216:217], v30 offset:24576
  v_mfma_f32_16x16x32_bf16 v[192:195], a[76:79], v[84:87], v[192:195]
  ds_read_b64_tr_b16 a[218:219], v30 offset:26624
  s_waitcnt vmcnt(11)
  v_mfma_f32_16x16x32_bf16 v[88:91], a[64:67], v[96:99], v[88:91]
  s_add_u32 s51, s46, s10
  v_mfma_f32_16x16x32_bf16 v[92:95], a[68:71], v[96:99], v[92:95]
  buffer_load_dwordx4 v[36:39], v246, s[28:31], s51 offen offset:2048 sc1
  v_mfma_f32_16x16x32_bf16 v[140:143], a[72:75], v[96:99], v[140:143]
  ds_read_b64_tr_b16 a[220:221], v31 offset:24576
  v_mfma_f32_16x16x32_bf16 v[144:147], a[76:79], v[96:99], v[144:147]
  ds_read_b64_tr_b16 a[222:223], v31 offset:26624
  s_waitcnt vmcnt(11)
  v_mfma_f32_16x16x32_bf16 v[148:151], a[64:67], v[100:103], v[148:151]
  s_add_u32 s52, s46, s11
  v_mfma_f32_16x16x32_bf16 v[152:155], a[68:71], v[100:103], v[152:155]
  buffer_load_dwordx4 v[40:43], v246, s[28:31], s52 offen offset:2048 sc1
  v_mfma_f32_16x16x32_bf16 v[156:159], a[72:75], v[100:103], v[156:159]
  v_mfma_f32_16x16x32_bf16 v[160:163], a[76:79], v[100:103], v[160:163]
  s_waitcnt vmcnt(11)
  s_mov_b64 exec, 0xffff
  v_cmp_ne_u32_e64 vcc, s7, v3
  s_cbranch_vccnz L_pb_43
L_pb_back_44:
  s_mov_b64 exec, -1
  v_mfma_f32_16x16x32_bf16 v[164:167], a[80:83], v[104:107], v[164:167]
  s_add_u32 s51, s37, s19
  v_mfma_f32_16x16x32_bf16 v[168:171], a[84:87], v[104:107], v[168:171]
  buffer_load_dwordx4 v[48:51], v32, s[28:31], s51 offen offset:2048 sc1
  v_mfma_f32_16x16x32_bf16 v[172:175], a[88:91], v[104:107], v[172:175]
  v_mfma_f32_16x16x32_bf16 v[176:179], a[92:95], v[104:107], v[176:179]
  s_waitcnt vmcnt(11)
  v_mfma_f32_16x16x32_bf16 v[180:183], a[80:83], v[108:111], v[180:183]
  s_add_u32 s52, s38, s19
  v_mfma_f32_16x16x32_bf16 v[184:187], a[84:87], v[108:111], v[184:187]
  buffer_load_dwordx4 v[52:55], v32, s[28:31], s52 offen offset:2048 sc1
  v_mfma_f32_16x16x32_bf16 v[188:191], a[88:91], v[108:111], v[188:191]
  v_mfma_f32_16x16x32_bf16 v[192:195], a[92:95], v[108:111], v[192:195]
  s_waitcnt vmcnt(11)
  v_mfma_f32_16x16x32_bf16 v[88:91], a[80:83], v[112:115], v[88:91]
  s_add_u32 s51, s37, s18
  v_mfma_f32_16x16x32_bf16 v[92:95], a[84:87], v[112:115], v[92:95]
  buffer_load_dwordx4 v[56:59], v32, s[28:31], s51 offen offset:2048 sc1
  v_mfma_f32_16x16x32_bf16 v[140:143], a[88:91], v[112:115], v[140:143]
  v_mfma_f32_16x16x32_bf16 v[144:147], a[92:95], v[112:115], v[144:147]
  s_waitcnt vmcnt(11)
  v_mfma_f32_16x16x32_bf16 v[148:151], a[80:83], v[116:119], v[148:151]
  s_add_u32 s52, s38, s18
  v_mfma_f32_16x16x32_bf16 v[152:155], a[84:87], v[116:119], v[152:155]
  buffer_load_dwordx4 v[60:63], v32, s[28:31], s52 offen offset:2048 sc1
  v_mfma_f32_16x16x32_bf16 v[156:159], a[88:91], v[116:119], v[156:159]
  v_mfma_f32_16x16x32_bf16 v[160:163], a[92:95], v[116:119], v[160:163]
  s_waitcnt vmcnt(11)
  v_mfma_f32_16x16x32_bf16 v[164:167], a[96:99], v[4:7], v[164:167]
  s_add_u32 s51, s39, s19
  v_mfma_f32_16x16x32_bf16 v[168:171], a[100:103], v[4:7], v[168:171]
  buffer_load_dwordx4 v[64:67], v32, s[28:31], s51 offen offset:2048 sc1
  v_mfma_f32_16x16x32_bf16 v[172:175], a[104:107], v[4:7], v[172:175]
  v_mfma_f32_16x16x32_bf16 v[176:179], a[108:111], v[4:7], v[176:179]
  s_waitcnt vmcnt(11)
  v_mfma_f32_16x16x32_bf16 v[180:183], a[96:99], v[8:11], v[180:183]
  s_add_u32 s52, s40, s19
  v_mfma_f32_16x16x32_bf16 v[184:187], a[100:103], v[8:11], v[184:187]
  buffer_load_dwordx4 v[68:71], v32, s[28:31], s52 offen offset:2048 sc1
  v_mfma_f32_16x16x32_bf16 v[188:191], a[104:107], v[8:11], v[188:191]
  v_mfma_f32_16x16x32_bf16 v[192:195], a[108:111], v[8:11], v[192:195]
  s_waitcnt vmcnt(11)
  v_mfma_f32_16x16x32_bf16 v[88:91], a[96:99], v[12:15], v[88:91]
  s_add_u32 s51, s39, s18
  v_mfma_f32_16x16x32_bf16 v[92:95], a[100:103], v[12:15], v[92:95]
  buffer_load_dwordx4 v[72:75], v32, s[28:31], s51 offen offset:2048 sc1
  v_mfma_f32_16x16x32_bf16 v[140:143], a[104:107], v[12:15], v[140:143]
  v_mfma_f32_16x16x32_bf16 v[144:147], a[108:111], v[12:15], v[144:147]
  s_waitcnt vmcnt(11)
  v_mfma_f32_16x16x32_bf16 v[148:151], a[96:99], v[16:19], v[148:151]
  s_add_u32 s52, s40, s18
  v_mfma_f32_16x16x32_bf16 v[152:155], a[100:103], v[16:19], v[152:155]
  buffer_load_dwordx4 v[76:79], v32, s[28:31], s52 offen offset:2048 sc1
  v_mfma_f32_16x16x32_bf16 v[156:159], a[104:107], v[16:19], v[156:159]
  v_mfma_f32_16x16x32_bf16 v[160:163], a[108:111], v[16:19], v[160:163]
  s_waitcnt vmcnt(11)
  s_waitcnt lgkmcnt(15)
  v_mfma_f32_16x16x32_bf16 v[164:167], a[112:115], v[20:23], v[164:167]
  s_add_u32 s51, s43, s17
  v_mfma_f32_16x16x32_bf16 v[168:171], a[116:119], v[20:23], v[168:171]
  buffer_load_dwordx4 v[80:83], v32, s[28:31], s51 offen offset:0 sc1
  v_mfma_f32_16x16x32_bf16 v[172:175], a[120:123], v[20:23], v[172:175]
  v_mfma_f32_16x16x32_bf16 v[176:179], a[124:127], v[20:23], v[176:179]
  s_waitcnt vmcnt(11)
  v_mfma_f32_16x16x32_bf16 v[180:183], a[112:115], v[24:27], v[180:183]
  s_add_u32 s52, s44, s17
  v_mfma_f32_16x16x32_bf16 v[184:187], a[116:119], v[24:27], v[184:187]
  buffer_load_dwordx4 v[84:87], v32, s[28:31], s52 offen offset:0 sc1
  v_mfma_f32_16x16x32_bf16 v[188:191], a[120:123], v[24:27], v[188:191]
  v_mfma_f32_16x16x32_bf16 v[192:195], a[124:127], v[24:27], v[192:195]
  s_waitcnt vmcnt(11)
  v_mfma_f32_16x16x32_bf16 v[88:91], a[112:115], v[36:39], v[88:91]
  s_add_u32 s51, s45, s17
  v_mfma_f32_16x16x32_bf16 v[92:95], a[116:119], v[36:39], v[92:95]
  buffer_load_dwordx4 v[96:99], v32, s[28:31], s51 offen offset:0 sc1
  v_mfma_f32_16x16x32_bf16 v[140:143], a[120:123], v[36:39], v[140:143]
  v_mfma_f32_16x16x32_bf16 v[144:147], a[124:127], v[36:39], v[144:147]
  s_waitcnt vmcnt(11)
  v_mfma_f32_16x16x32_bf16 v[148:151], a[112:115], v[40:43], v[148:151]
  s_add_u32 s52, s46, s17
  v_mfma_f32_16x16x32_bf16 v[152:155], a[116:119], v[40:43], v[152:155]
  buffer_load_dwordx4 v[100:103], v32, s[28:31], s52 offen offset:0 sc1
  v_mfma_f32_16x16x32_bf16 v[156:159], a[120:123], v[40:43], v[156:159]
  v_mfma_f32_16x16x32_bf16 v[160:163], a[124:127], v[40:43], v[160:163]
  s_waitcnt vmcnt(10)
  s_mov_b64 exec, s[66:67]
  v_swap_b32 v50, v52
  v_swap_b32 v51, v53
  s_mov_b64 exec, s[72:73]
  v_swap_b32 v48, v54
  v_swap_b32 v49, v55
  s_mov_b64 exec, -1
  s_nop 0
  v_mfma_f32_16x16x32_bf16 v[164:167], a[128:131], v[48:51], v[164:167]
  s_add_u32 s51, s43, s16
  v_mfma_f32_16x16x32_bf16 v[168:171], a[132:135], v[48:51], v[168:171]
  buffer_load_dwordx4 v[104:107], v32, s[28:31], s51 offen offset:0 sc1
  v_mfma_f32_16x16x32_bf16 v[172:175], a[136:139], v[48:51], v[172:175]
  v_mfma_f32_16x16x32_bf16 v[176:179], a[140:143], v[48:51], v[176:179]
  v_mfma_f32_16x16x32_bf16 v[180:183], a[128:131], v[52:55], v[180:183]
  s_add_u32 s52, s44, s16
  v_mfma_f32_16x16x32_bf16 v[184:187], a[132:135], v[52:55], v[184:187]
  buffer_load_dwordx4 v[108:111], v32, s[28:31], s52 offen offset:0 sc1
  v_mfma_f32_16x16x32_bf16 v[188:191], a[136:139], v[52:55], v[188:191]
  v_mfma_f32_16x16x32_bf16 v[192:195], a[140:143], v[52:55], v[192:195]
  s_waitcnt vmcnt(10)
  s_mov_b64 exec, s[66:67]
  v_swap_b32 v58, v60
  v_swap_b32 v59, v61
  s_mov_b64 exec, s[72:73]
  v_swap_b32 v56, v62
  v_swap_b32 v57, v63
  s_mov_b64 exec, -1
  s_nop 0
  v_mfma_f32_16x16x32_bf16 v[88:91], a[128:131], v[56:59], v[88:91]
  s_add_u32 s51, s45, s16
  v_mfma_f32_16x16x32_bf16 v[92:95], a[132:135], v[56:59], v[92:95]
  buffer_load_dwordx4 v[112:115], v32, s[28:31], s51 offen offset:0 sc1
  v_mfma_f32_16x16x32_bf16 v[140:143], a[136:139], v[56:59], v[140:143]
  v_mfma_f32_16x16x32_bf16 v[144:147], a[140:143], v[56:59], v[144:147]
  v_mfma_f32_16x16x32_bf16 v[148:151], a[128:131], v[60:63], v[148:151]
  s_add_u32 s52, s46, s16
  v_mfma_f32_16x16x32_bf16 v[152:155], a[132:135], v[60:63], v[152:155]
  buffer_load_dwordx4 v[116:119], v32, s[28:31], s52 offen offset:0 sc1
  v_mfma_f32_16x16x32_bf16 v[156:159], a[136:139], v[60:63], v[156:159]
  v_mfma_f32_16x16x32_bf16 v[160:163], a[140:143], v[60:63], v[160:163]
  s_waitcnt vmcnt(10)
  s_mov_b64 exec, s[66:67]
  v_swap_b32 v66, v68
  v_swap_b32 v67, v69
  s_mov_b64 exec, s[72:73]
  v_swap_b32 v64, v70
  v_swap_b32 v65, v71
  s_mov_b64 exec, -1
  s_nop 0
  v_mfma_f32_16x16x32_bf16 v[164:167], a[144:147], v[64:67], v[164:167]
  s_add_u32 s51, s43, s11
  v_mfma_f32_16x16x32_bf16 v[168:171], a[148:151], v[64:67], v[168:171]
  buffer_load_dwordx4 v[4:7], v32, s[28:31], s51 offen offset:0 sc1
  v_mfma_f32_16x16x32_bf16 v[172:175], a[152:155], v[64:67], v[172:175]
  v_mfma_f32_16x16x32_bf16 v[176:179], a[156:159], v[64:67], v[176:179]
  v_mfma_f32_16x16x32_bf16 v[180:183], a[144:147], v[68:71], v[180:183]
  s_add_u32 s52, s44, s11
  v_mfma_f32_16x16x32_bf16 v[184:187], a[148:151], v[68:71], v[184:187]
  buffer_load_dwordx4 v[8:11], v32, s[28:31], s52 offen offset:0 sc1
  v_mfma_f32_16x16x32_bf16 v[188:191], a[152:155], v[68:71], v[188:191]
  v_mfma_f32_16x16x32_bf16 v[192:195], a[156:159], v[68:71], v[192:195]
  s_waitcnt vmcnt(10)
  s_mov_b64 exec, s[66:67]
  v_swap_b32 v74, v76
  v_swap_b32 v75, v77
  s_mov_b64 exec, s[72:73]
  v_swap_b32 v72, v78
  v_swap_b32 v73, v79
  s_mov_b64 exec, -1
  s_nop 0
  v_mfma_f32_16x16x32_bf16 v[88:91], a[144:147], v[72:75], v[88:91]
  s_add_u32 s51, s45, s11
  v_mfma_f32_16x16x32_bf16 v[92:95], a[148:151], v[72:75], v[92:95]
  buffer_load_dwordx4 v[12:15], v32, s[28:31], s51 offen offset:0 sc1
  v_mfma_f32_16x16x32_bf16 v[140:143], a[152:155], v[72:75], v[140:143]
  v_mfma_f32_16x16x32_bf16 v[144:147], a[156:159], v[72:75], v[144:147]
  v_mfma_f32_16x16x32_bf16 v[148:151], a[144:147], v[76:79], v[148:151]
  s_add_u32 s52, s46, s11
  v_mfma_f32_16x16x32_bf16 v[152:155], a[148:151], v[76:79], v[152:155]
  buffer_load_dwordx4 v[16:19], v32, s[28:31], s52 offen offset:0 sc1
  v_mfma_f32_16x16x32_bf16 v[156:159], a[152:155], v[76:79], v[156:159]
  v_mfma_f32_16x16x32_bf16 v[160:163], a[156:159], v[76:79], v[160:163]
  s_waitcnt vmcnt(11)
  v_mfma_f32_16x16x32_bf16 v[180:183], a[160:163], v[80:83], v[180:183]
  s_add_u32 s51, s43, s10
  v_mfma_f32_16x16x32_bf16 v[184:187], a[164:167], v[80:83], v[184:187]
  buffer_load_dwordx4 v[20:23], v32, s[28:31], s51 offen offset:0 sc1
  v_mfma_f32_16x16x32_bf16 v[188:191], a[168:171], v[80:83], v[188:191]
  v_mfma_f32_16x16x32_bf16 v[192:195], a[172:175], v[80:83], v[192:195]
  s_waitcnt vmcnt(11)
  v_mfma_f32_16x16x32_bf16 v[180:183], a[176:179], v[84:87], v[180:183]
  s_add_u32 s52, s44, s10
  v_mfma_f32_16x16x32_bf16 v[184:187], a[180:183], v[84:87], v[184:187]
  buffer_load_dwordx4 v[24:27], v32, s[28:31], s52 offen offset:0 sc1
  v_mfma_f32_16x16x32_bf16 v[188:191], a[184:187], v[84:87], v[188:191]
  v_mfma_f32_16x16x32_bf16 v[192:195], a[188:191], v[84:87], v[192:195]
  s_waitcnt vmcnt(11)
  s_waitcnt lgkmcnt(8)
  v_mfma_f32_16x16x32_bf16 v[180:183], a[192:195], v[96:99], v[180:183]
  s_add_u32 s51, s45, s10
  v_mfma_f32_16x16x32_bf16 v[184:187], a[196:199], v[96:99], v[184:187]
  buffer_load_dwordx4 v[36:39], v32, s[28:31], s51 offen offset:0 sc1
  v_mfma_f32_16x16x32_bf16 v[188:191], a[200:203], v[96:99], v[188:191]
  v_mfma_f32_16x16x32_bf16 v[192:195], a[204:207], v[96:99], v[192:195]
  s_waitcnt vmcnt(11)
  s_waitcnt lgkmcnt(0)
  v_mfma_f32_16x16x32_bf16 v[180:183], a[208:211], v[100:103], v[180:183]
  s_add_u32 s52, s46, s10
  v_mfma_f32_16x16x32_bf16 v[184:187], a[212:215], v[100:103], v[184:187]
  buffer_load_dwordx4 v[40:43], v32, s[28:31], s52 offen offset:0 sc1
  v_mfma_f32_16x16x32_bf16 v[188:191], a[216:219], v[100:103], v[188:191]
  v_mfma_f32_16x16x32_bf16 v[192:195], a[220:223], v[100:103], v[192:195]
  s_waitcnt vmcnt(11)
  v_mfma_f32_16x16x32_bf16 v[164:167], a[160:163], v[104:107], v[164:167]
  v_mfma_f32_16x16x32_bf16 v[168:171], a[164:167], v[104:107], v[168:171]
  v_mfma_f32_16x16x32_bf16 v[172:175], a[168:171], v[104:107], v[172:175]
  v_mfma_f32_16x16x32_bf16 v[176:179], a[172:175], v[104:107], v[176:179]
  s_waitcnt vmcnt(10)
  v_mfma_f32_16x16x32_bf16 v[164:167], a[176:179], v[108:111], v[164:167]
  ds_write_b128 v47, v[180:183] offset:0
  v_mfma_f32_16x16x32_bf16 v[168:171], a[180:183], v[108:111], v[168:171]
  v_mfma_f32_16x16x32_bf16 v[172:175], a[184:187], v[108:111], v[172:175]
  v_mfma_f32_16x16x32_bf16 v[176:179], a[188:191], v[108:111], v[176:179]
  s_waitcnt vmcnt(9)
  v_mfma_f32_16x16x32_bf16 v[164:167], a[192:195], v[112:115], v[164:167]
  ds_write_b128 v47, v[184:187] offset:1024
  v_mfma_f32_16x16x32_bf16 v[168:171], a[196:199], v[112:115], v[168:171]
  v_mfma_f32_16x16x32_bf16 v[172:175], a[200:203], v[112:115], v[172:175]
  v_mfma_f32_16x16x32_bf16 v[176:179], a[204:207], v[112:115], v[176:179]
  s_waitcnt vmcnt(8)
  v_mfma_f32_16x16x32_bf16 v[164:167], a[208:211], v[116:119], v[164:167]
  ds_write_b128 v47, v[188:191] offset:2048
  v_mfma_f32_16x16x32_bf16 v[168:171], a[212:215], v[116:119], v[168:171]
  ds_write_b128 v47, v[192:195] offset:3072
  v_mfma_f32_16x16x32_bf16 v[172:175], a[216:219], v[116:119], v[172:175]
  v_mfma_f32_16x16x32_bf16 v[176:179], a[220:223], v[116:119], v[176:179]
  s_waitcnt vmcnt(7)
  v_mfma_f32_16x16x32_bf16 v[148:151], a[160:163], v[4:7], v[148:151]
  v_mfma_f32_16x16x32_bf16 v[152:155], a[164:167], v[4:7], v[152:155]
  v_mfma_f32_16x16x32_bf16 v[156:159], a[168:171], v[4:7], v[156:159]
  v_mfma_f32_16x16x32_bf16 v[160:163], a[172:175], v[4:7], v[160:163]
  s_waitcnt vmcnt(6)
  v_mfma_f32_16x16x32_bf16 v[148:151], a[176:179], v[8:11], v[148:151]
  ds_write_b128 v46, v[164:167] offset:0
  v_mfma_f32_16x16x32_bf16 v[152:155], a[180:183], v[8:11], v[152:155]
  v_mfma_f32_16x16x32_bf16 v[156:159], a[184:187], v[8:11], v[156:159]
  v_mfma_f32_16x16x32_bf16 v[160:163], a[188:191], v[8:11], v[160:163]
  s_waitcnt vmcnt(5)
  v_mfma_f32_16x16x32_bf16 v[148:151], a[192:195], v[12:15], v[148:151]
  ds_write_b128 v46, v[168:171] offset:1024
  v_mfma_f32_16x16x32_bf16 v[152:155], a[196:199], v[12:15], v[152:155]
  v_mfma_f32_16x16x32_bf16 v[156:159], a[200:203], v[12:15], v[156:159]
  v_mfma_f32_16x16x32_bf16 v[160:163], a[204:207], v[12:15], v[160:163]
  s_waitcnt vmcnt(4)
  v_mfma_f32_16x16x32_bf16 v[148:151], a[208:211], v[16:19], v[148:151]
  ds_write_b128 v46, v[172:175] offset:2048
  v_mfma_f32_16x16x32_bf16 v[152:155], a[212:215], v[16:19], v[152:155]
  ds_write_b128 v46, v[176:179] offset:3072
  v_mfma_f32_16x16x32_bf16 v[156:159], a[216:219], v[16:19], v[156:159]
  v_mfma_f32_16x16x32_bf16 v[160:163], a[220:223], v[16:19], v[160:163]
  s_waitcnt vmcnt(3)
  v_mfma_f32_16x16x32_bf16 v[88:91], a[160:163], v[20:23], v[88:91]
  v_mfma_f32_16x16x32_bf16 v[92:95], a[164:167], v[20:23], v[92:95]
  v_mfma_f32_16x16x32_bf16 v[140:143], a[168:171], v[20:23], v[140:143]
  v_mfma_f32_16x16x32_bf16 v[144:147], a[172:175], v[20:23], v[144:147]
  s_waitcnt vmcnt(2)
  v_mfma_f32_16x16x32_bf16 v[88:91], a[176:179], v[24:27], v[88:91]
  ds_write_b128 v45, v[148:151] offset:0
  v_mfma_f32_16x16x32_bf16 v[92:95], a[180:183], v[24:27], v[92:95]
  v_mfma_f32_16x16x32_bf16 v[140:143], a[184:187], v[24:27], v[140:143]
  v_mfma_f32_16x16x32_bf16 v[144:147], a[188:191], v[24:27], v[144:147]
  s_waitcnt vmcnt(1)
  v_mfma_f32_16x16x32_bf16 v[88:91], a[192:195], v[36:39], v[88:91]
  ds_write_b128 v45, v[152:155] offset:1024
  v_mfma_f32_16x16x32_bf16 v[92:95], a[196:199], v[36:39], v[92:95]
  v_mfma_f32_16x16x32_bf16 v[140:143], a[200:203], v[36:39], v[140:143]
  v_mfma_f32_16x16x32_bf16 v[144:147], a[204:207], v[36:39], v[144:147]
  s_waitcnt vmcnt(0)
  v_mfma_f32_16x16x32_bf16 v[88:91], a[208:211], v[40:43], v[88:91]
  ds_write_b128 v45, v[156:159] offset:2048
  v_mfma_f32_16x16x32_bf16 v[92:95], a[212:215], v[40:43], v[92:95]
  ds_write_b128 v45, v[160:163] offset:3072
  v_mfma_f32_16x16x32_bf16 v[140:143], a[216:219], v[40:43], v[140:143]
  v_mfma_f32_16x16x32_bf16 v[144:147], a[220:223], v[40:43], v[144:147]
  s_or_b32 s53, s2, s3
  s_cmp_lg_u32 s53, 0
  s_cbranch_scc1 L_ep_46
  s_mov_b64 exec, 1
  buffer_store_dword v245, v244, s[28:31], 0 offen offset:0
  s_mov_b64 exec, -1
L_ep_46:
  s_lshl_b32 s51, s5, 7
  s_add_u32 s51, s51, s70
  s_add_u32 s52, s51, 8192
  s_waitcnt lgkmcnt(0)
  s_barrier
  ds_read_b128 v[120:123], v33 offset:8192
  ds_read_b128 v[124:127], v33 offset:9216
  ds_read_b128 v[128:131], v33 offset:10240
  ds_read_b128 v[132:135], v33 offset:11264
  ds_read_b128 v[136:139], v33 offset:4096
  ds_read_b128 v[196:199], v33 offset:5120
  ds_read_b128 v[200:203], v33 offset:6144
  ds_read_b128 v[204:207], v33 offset:7168
  ds_read_b128 v[4:7], v33 offset:0
  ds_read_b128 v[8:11], v33 offset:1024
  ds_read_b128 v[12:15], v33 offset:2048
  ds_read_b128 v[16:19], v33 offset:3072
  s_waitcnt lgkmcnt(4)
  v_pk_add_f32 v[120:121], v[120:121], v[136:137]
  v_pk_add_f32 v[122:123], v[122:123], v[138:139]
  v_pk_add_f32 v[124:125], v[124:125], v[196:197]
  v_pk_add_f32 v[126:127], v[126:127], v[198:199]
  v_pk_add_f32 v[128:129], v[128:129], v[200:201]
  v_pk_add_f32 v[130:131], v[130:131], v[202:203]
  v_pk_add_f32 v[132:133], v[132:133], v[204:205]
  v_pk_add_f32 v[134:135], v[134:135], v[206:207]
  v_pk_add_f32 v[88:89], v[88:89], v[120:121]
  v_pk_add_f32 v[90:91], v[90:91], v[122:123]
  v_pk_add_f32 v[92:93], v[92:93], v[124:125]
  v_pk_add_f32 v[94:95], v[94:95], v[126:127]
  v_pk_add_f32 v[140:141], v[140:141], v[128:129]
  v_pk_add_f32 v[142:143], v[142:143], v[130:131]
  v_pk_add_f32 v[144:145], v[144:145], v[132:133]
  v_pk_add_f32 v[146:147], v[146:147], v[134:135]
  s_waitcnt lgkmcnt(3)
  v_pk_add_f32 v[88:89], v[88:89], v[4:5]
  v_pk_add_f32 v[90:91], v[90:91], v[6:7]
  v_cvt_pk_bf16_f32 v20, v88, v89
  v_cvt_pk_bf16_f32 v21, v90, v91
  ds_write_b64 v34, v[20:21] offset:0
  s_waitcnt lgkmcnt(3)
  v_pk_add_f32 v[92:93], v[92:93], v[8:9]
  v_pk_add_f32 v[94:95], v[94:95], v[10:11]
  v_cvt_pk_bf16_f32 v22, v92, v93
  v_cvt_pk_bf16_f32 v23, v94, v95
  ds_write_b64 v34, v[22:23] offset:32
  s_waitcnt lgkmcnt(3)
  v_pk_add_f32 v[140:141], v[140:141], v[12:13]
  v_pk_add_f32 v[142:143], v[142:143], v[14:15]
  v_cvt_pk_bf16_f32 v24, v140, v141
  v_cvt_pk_bf16_f32 v25, v142, v143
  ds_write_b64 v34, v[24:25] offset:64
  s_waitcnt lgkmcnt(3)
  v_pk_add_f32 v[144:145], v[144:145], v[16:17]
  v_pk_add_f32 v[146:147], v[146:147], v[18:19]
  v_cvt_pk_bf16_f32 v26, v144, v145
  v_cvt_pk_bf16_f32 v27, v146, v147
  ds_write_b64 v34, v[26:27] offset:96
  ds_read_b128 v[36:39], v35 offset:0
  ds_read_b128 v[40:43], v35 offset:1152
  s_waitcnt lgkmcnt(1)
  buffer_store_dwordx4 v[36:39], v44, s[32:35], s51 offen
  s_waitcnt lgkmcnt(0)
  buffer_store_dwordx4 v[40:43], v44, s[32:35], s52 offen
L_end:
  s_endpgm
L_own_3:
  s_waitcnt vmcnt(12)
  v_xor_b32 v64, v31, v245
  v_xor_b32 v65, v35, v245
  v_xor_b32_e64 v66, v39, v245
  v_or3_b32 v64, v64, v65, v66
  v_xor_b32 v65, v43, v245
  v_xor_b32 v66, v47, v245
  v_or3_b32 v64, v64, v65, v66
  v_xor_b32 v65, v51, v245
  v_xor_b32 v66, v55, v245
  v_or3_b32 v64, v64, v65, v66
  v_xor_b32 v65, v59, v245
  v_or_b32 v64, v64, v65
  v_cmp_ne_u32 vcc, 0, v64
  s_cbranch_vccz L_own_go_6
  buffer_load_dwordx4 v[28:31], v246, s[28:31], s6 offen offset:0 sc1
  buffer_load_dwordx4 v[32:35], v246, s[28:31], s6 offen offset:1024 sc1
  buffer_load_dwordx4 v[36:39], v246, s[28:31], s6 offen offset:2048 sc1
  buffer_load_dwordx4 v[40:43], v246, s[28:31], s6 offen offset:3072 sc1
  buffer_load_dwordx4 v[44:47], v246, s[28:31], s41 offen offset:0 sc1
  buffer_load_dwordx4 v[48:51], v246, s[28:31], s41 offen offset:1024 sc1
  buffer_load_dwordx4 v[52:55], v246, s[28:31], s41 offen offset:2048 sc1
  buffer_load_dwordx4 v[56:59], v246, s[28:31], s41 offen offset:3072 sc1
  s_branch L_own_back_4
L_own_go_6:
  v_mfma_f32_16x16x16_bf16 v[60:63], v[204:205], v[28:29], 0
  v_mfma_f32_16x16x16_bf16 v[60:63], v[204:205], v[32:33], v[60:63]
  v_mfma_f32_16x16x16_bf16 v[60:63], v[204:205], v[36:37], v[60:63]
  v_mfma_f32_16x16x16_bf16 v[60:63], v[204:205], v[40:41], v[60:63]
  v_mfma_f32_16x16x16_bf16 v[60:63], v[204:205], v[44:45], v[60:63]
  v_mfma_f32_16x16x16_bf16 v[60:63], v[204:205], v[48:49], v[60:63]
  v_mfma_f32_16x16x16_bf16 v[60:63], v[204:205], v[52:53], v[60:63]
  v_mfma_f32_16x16x16_bf16 v[60:63], v[204:205], v[56:57], v[60:63]
  v_add_f32 v64, v30, v34
  v_add_f32 v65, v38, v42
  v_add_f32 v66, v46, v50
  v_add_f32 v67, v54, v58
  v_add_f32 v64, v64, v65
  v_add_f32 v66, v66, v67
  v_add_f32 v64, v64, v66
  v_mov_b32 v65, v64
  s_lshr_b32 s40, s6, 5
  s_nop 0
  v_permlane32_swap_b32 v64, v65
  v_add_f32 v64, v64, v65
  v_mov_b32 v65, v64
  s_add_u32 s40, s40, 0
  s_nop 0
  v_permlane16_swap_b32 v64, v65
  v_add_f32 v64, v64, v65
  v_mov_b32_e64 v31, v245
  v_cvt_pk_bf16_f32 v28, v60, v61
  v_mov_b32_dpp v65, v64 quad_perm:[0,2,0,2] row_mask:0xf bank_mask:0xf
  v_mov_b32_dpp v66, v64 quad_perm:[1,3,1,3] row_mask:0xf bank_mask:0xf
  v_cvt_pk_bf16_f32 v29, v62, v63
  v_cvt_pk_bf16_f32 v30, v65, v66
  s_mov_b64 exec, 0xffff
  buffer_store_dwordx4 v[28:31], v246, s[28:31], s40 offen sc1
  s_mov_b64 exec, -1
  s_branch L_own_back_4
L_own_9:
  s_waitcnt vmcnt(7)
  v_xor_b32 v64, v31, v245
  v_xor_b32 v65, v35, v245
  v_xor_b32 v66, v39, v245
  v_or3_b32 v64, v64, v65, v66
  v_xor_b32 v65, v43, v245
  v_xor_b32 v66, v47, v245
  v_or3_b32 v64, v64, v65, v66
  v_xor_b32 v65, v51, v245
  v_xor_b32 v66, v55, v245
  v_or3_b32 v64, v64, v65, v66
  v_xor_b32 v65, v59, v245
  v_or_b32 v64, v64, v65
  v_cmp_ne_u32 vcc, 0, v64
  s_cbranch_vccz L_own_go_12
  buffer_load_dwordx4 v[28:31], v246, s[28:31], s6 offen offset:0 sc1
  buffer_load_dwordx4 v[32:35], v246, s[28:31], s6 offen offset:1024 sc1
  buffer_load_dwordx4 v[36:39], v246, s[28:31], s6 offen offset:2048 sc1
  buffer_load_dwordx4 v[40:43], v246, s[28:31], s6 offen offset:3072 sc1
  buffer_load_dwordx4 v[44:47], v246, s[28:31], s41 offen offset:0 sc1
  buffer_load_dwordx4 v[48:51], v246, s[28:31], s41 offen offset:1024 sc1
  buffer_load_dwordx4 v[52:55], v246, s[28:31], s41 offen offset:2048 sc1
  buffer_load_dwordx4 v[56:59], v246, s[28:31], s41 offen offset:3072 sc1
  s_branch L_own_back_10
L_own_go_12:
  v_mfma_f32_16x16x16_bf16 v[60:63], v[204:205], v[28:29], 0
  v_mfma_f32_16x16x16_bf16 v[60:63], v[204:205], v[32:33], v[60:63]
  v_mfma_f32_16x16x16_bf16 v[60:63], v[204:205], v[36:37], v[60:63]
  v_mfma_f32_16x16x16_bf16 v[60:63], v[204:205], v[40:41], v[60:63]
  v_mfma_f32_16x16x16_bf16 v[60:63], v[204:205], v[44:45], v[60:63]
  v_mfma_f32_16x16x16_bf16 v[60:63], v[204:205], v[48:49], v[60:63]
  v_mfma_f32_16x16x16_bf16 v[60:63], v[204:205], v[52:53], v[60:63]
  v_mfma_f32_16x16x16_bf16 v[60:63], v[204:205], v[56:57], v[60:63]
  v_add_f32 v64, v30, v34
  v_add_f32 v65, v38, v42
  v_add_f32 v66, v46, v50
  v_add_f32 v67, v54, v58
  v_add_f32 v64, v64, v65
  v_add_f32 v66, v66, v67
  v_add_f32 v64, v64, v66
  v_mov_b32 v65, v64
  s_lshr_b32 s40, s6, 5
  s_nop 0
  v_permlane32_swap_b32 v64, v65
  v_add_f32 v64, v64, v65
  v_mov_b32 v65, v64
  s_add_u32 s40, s40, 0
  s_nop 0
  v_permlane16_swap_b32 v64, v65
  v_add_f32 v64, v64, v65
  v_mov_b32_e64 v31, v245
  v_cvt_pk_bf16_f32 v28, v60, v61
  v_mov_b32_dpp v65, v64 quad_perm:[0,2,0,2] row_mask:0xf bank_mask:0xf
  v_mov_b32_dpp v66, v64 quad_perm:[1,3,1,3] row_mask:0xf bank_mask:0xf
  v_cvt_pk_bf16_f32 v29, v62, v63
  v_cvt_pk_bf16_f32 v30, v65, v66
  s_mov_b64 exec, 0xffff
  buffer_store_dwordx4 v[28:31], v246, s[28:31], s40 offen sc1
  s_mov_b64 exec, -1
  s_branch L_own_back_10
L_own_13:
  s_waitcnt vmcnt(6)
  v_xor_b32 v64, v31, v245
  v_xor_b32 v65, v35, v245
  v_xor_b32 v66, v39, v245
  v_or3_b32 v64, v64, v65, v66
  v_xor_b32 v65, v43, v245
  v_xor_b32 v66, v47, v245
  v_or3_b32 v64, v64, v65, v66
  v_xor_b32 v65, v51, v245
  v_xor_b32 v66, v55, v245
  v_or3_b32 v64, v64, v65, v66
  v_xor_b32 v65, v59, v245
  v_or_b32 v64, v64, v65
  v_cmp_ne_u32 vcc, 0, v64
  s_cbranch_vccz L_own_go_16
  buffer_load_dwordx4 v[28:31], v246, s[28:31], s6 offen offset:0 sc1
  buffer_load_dwordx4 v[32:35], v246, s[28:31], s6 offen offset:1024 sc1
  buffer_load_dwordx4 v[36:39], v246, s[28:31], s6 offen offset:2048 sc1
  buffer_load_dwordx4 v[40:43], v246, s[28:31], s6 offen offset:3072 sc1
  buffer_load_dwordx4 v[44:47], v246, s[28:31], s41 offen offset:0 sc1
  buffer_load_dwordx4 v[48:51], v246, s[28:31], s41 offen offset:1024 sc1
  buffer_load_dwordx4 v[52:55], v246, s[28:31], s41 offen offset:2048 sc1
  buffer_load_dwordx4 v[56:59], v246, s[28:31], s41 offen offset:3072 sc1
  s_branch L_own_back_14
L_own_go_16:
  v_mfma_f32_16x16x16_bf16 v[60:63], v[204:205], v[28:29], 0
  v_mfma_f32_16x16x16_bf16 v[60:63], v[204:205], v[32:33], v[60:63]
  v_mfma_f32_16x16x16_bf16 v[60:63], v[204:205], v[36:37], v[60:63]
  v_mfma_f32_16x16x16_bf16 v[60:63], v[204:205], v[40:41], v[60:63]
  v_mfma_f32_16x16x16_bf16 v[60:63], v[204:205], v[44:45], v[60:63]
  v_mfma_f32_16x16x16_bf16 v[60:63], v[204:205], v[48:49], v[60:63]
  v_mfma_f32_16x16x16_bf16 v[60:63], v[204:205], v[52:53], v[60:63]
  v_mfma_f32_16x16x16_bf16 v[60:63], v[204:205], v[56:57], v[60:63]
  v_add_f32 v64, v30, v34
  v_add_f32 v65, v38, v42
  v_add_f32 v66, v46, v50
  v_add_f32 v67, v54, v58
  v_add_f32 v64, v64, v65
  v_add_f32 v66, v66, v67
  v_add_f32 v64, v64, v66
  v_mov_b32 v65, v64
  s_lshr_b32 s40, s6, 5
  s_nop 0
  v_permlane32_swap_b32 v64, v65
  v_add_f32 v64, v64, v65
  v_mov_b32 v65, v64
  s_add_u32 s40, s40, 0
  s_nop 0
  v_permlane16_swap_b32 v64, v65
  v_add_f32 v64, v64, v65
  v_mov_b32_e64 v31, v245
  v_cvt_pk_bf16_f32 v28, v60, v61
  v_mov_b32_dpp v65, v64 quad_perm:[0,2,0,2] row_mask:0xf bank_mask:0xf
  v_mov_b32_dpp v66, v64 quad_perm:[1,3,1,3] row_mask:0xf bank_mask:0xf
  v_cvt_pk_bf16_f32 v29, v62, v63
  v_cvt_pk_bf16_f32 v30, v65, v66
  s_mov_b64 exec, 0xffff
  buffer_store_dwordx4 v[28:31], v246, s[28:31], s40 offen sc1
  s_mov_b64 exec, -1
  s_branch L_own_back_14
L_own_17:
  s_waitcnt vmcnt(9)
  s_mov_b32 s57, 0
L_own_chk_19:
  v_xor_b32 v64, v31, v245
  v_xor_b32 v65, v35, v245
  v_xor_b32_e64 v66, v39, v245
  v_or3_b32 v64, v64, v65, v66
  v_xor_b32 v65, v43, v245
  v_xor_b32 v66, v47, v245
  v_or3_b32 v64, v64, v65, v66
  v_xor_b32 v65, v51, v245
  v_xor_b32 v66, v55, v245
  v_or3_b32 v64, v64, v65, v66
  v_xor_b32 v65, v59, v245
  v_or_b32 v64, v64, v65
  v_cmp_ne_u32_e64 vcc, 0, v64
  s_cbranch_vccz L_own_go_20
  s_add_u32 s57, s57, 1
  s_cmp_gt_u32 s57, 262144
  s_cbranch_scc1 L_own_go_20
  buffer_load_dwordx4 v[28:31], v246, s[28:31], s6 offen offset:0 sc1
  buffer_load_dwordx4 v[32:35], v246, s[28:31], s6 offen offset:1024 sc1
  buffer_load_dwordx4 v[36:39], v246, s[28:31], s6 offen offset:2048 sc1
  buffer_load_dwordx4 v[40:43], v246, s[28:31], s6 offen offset:3072 sc1
  buffer_load_dwordx4 v[44:47], v246, s[28:31], s41 offen offset:0 sc1
  buffer_load_dwordx4 v[48:51], v246, s[28:31], s41 offen offset:1024 sc1
  buffer_load_dwordx4 v[52:55], v246, s[28:31], s41 offen offset:2048 sc1
  buffer_load_dwordx4 v[56:59], v246, s[28:31], s41 offen offset:3072 sc1
  s_waitcnt vmcnt(0)
  s_branch L_own_chk_19
L_own_go_20:
  v_mfma_f32_16x16x16_bf16 v[60:63], v[204:205], v[28:29], 0
  v_mfma_f32_16x16x16_bf16 v[60:63], v[204:205], v[32:33], v[60:63]
  v_mfma_f32_16x16x16_bf16 v[60:63], v[204:205], v[36:37], v[60:63]
  v_mfma_f32_16x16x16_bf16 v[60:63], v[204:205], v[40:41], v[60:63]
  v_mfma_f32_16x16x16_bf16 v[60:63], v[204:205], v[44:45], v[60:63]
  v_mfma_f32_16x16x16_bf16 v[60:63], v[204:205], v[48:49], v[60:63]
  v_mfma_f32_16x16x16_bf16 v[60:63], v[204:205], v[52:53], v[60:63]
  v_mfma_f32_16x16x16_bf16 v[60:63], v[204:205], v[56:57], v[60:63]
  v_add_f32 v64, v30, v34
  v_add_f32 v65, v38, v42
  v_add_f32 v66, v46, v50
  v_add_f32 v67, v54, v58
  v_add_f32 v64, v64, v65
  v_add_f32 v66, v66, v67
  v_add_f32 v64, v64, v66
  v_mov_b32 v65, v64
  s_lshr_b32 s40, s6, 5
  s_nop 0
  v_permlane32_swap_b32 v64, v65
  v_add_f32 v64, v64, v65
  v_mov_b32 v65, v64
  s_add_u32 s40, s40, 0
  s_nop 0
  v_permlane16_swap_b32 v64, v65
  v_add_f32 v64, v64, v65
  v_mov_b32_e64 v31, v245
  v_cvt_pk_bf16_f32 v28, v60, v61
  v_mov_b32_dpp v65, v64 quad_perm:[0,2,0,2] row_mask:0xf bank_mask:0xf
  v_mov_b32_dpp v66, v64 quad_perm:[1,3,1,3] row_mask:0xf bank_mask:0xf
  v_cvt_pk_bf16_f32 v29, v62, v63
  v_cvt_pk_bf16_f32 v30, v65, v66
  s_mov_b64 exec, 0xffff
  buffer_store_dwordx4 v[28:31], v246, s[28:31], s40 offen sc1
  s_mov_b64 exec, -1
  s_branch L_own_back_18
L_own_21:
  s_waitcnt vmcnt(0)
  s_mov_b32 s57, 0
L_own_chk_23:
  v_xor_b32 v64, v31, v245
  v_xor_b32 v65, v35, v245
  v_xor_b32_e64 v66, v39, v245
  v_or3_b32 v64, v64, v65, v66
  v_xor_b32 v65, v43, v245
  v_xor_b32 v66, v47, v245
  v_or3_b32 v64, v64, v65, v66
  v_xor_b32 v65, v51, v245
  v_xor_b32 v66, v55, v245
  v_or3_b32 v64, v64, v65, v66
  v_xor_b32 v65, v59, v245
  v_or_b32 v64, v64, v65
  v_cmp_ne_u32_e64 vcc, 0, v64
  s_cbranch_vccz L_own_go_24
  s_add_u32 s57, s57, 1
  s_cmp_gt_u32 s57, 262144
  s_cbranch_scc1 L_own_go_24
  buffer_load_dwordx4 v[28:31], v246, s[28:31], s6 offen offset:0 sc1
  buffer_load_dwordx4 v[32:35], v246, s[28:31], s6 offen offset:1024 sc1
  buffer_load_dwordx4 v[36:39], v246, s[28:31], s6 offen offset:2048 sc1
  buffer_load_dwordx4 v[40:43], v246, s[28:31], s6 offen offset:3072 sc1
  buffer_load_dwordx4 v[44:47], v246, s[28:31], s41 offen offset:0 sc1
  buffer_load_dwordx4 v[48:51], v246, s[28:31], s41 offen offset:1024 sc1
  buffer_load_dwordx4 v[52:55], v246, s[28:31], s41 offen offset:2048 sc1
  buffer_load_dwordx4 v[56:59], v246, s[28:31], s41 offen offset:3072 sc1
  s_waitcnt vmcnt(0)
  s_branch L_own_chk_23
L_own_go_24:
  v_mfma_f32_16x16x16_bf16 v[60:63], v[204:205], v[28:29], 0
  v_mfma_f32_16x16x16_bf16 v[60:63], v[204:205], v[32:33], v[60:63]
  v_mfma_f32_16x16x16_bf16 v[60:63], v[204:205], v[36:37], v[60:63]
  v_mfma_f32_16x16x16_bf16 v[60:63], v[204:205], v[40:41], v[60:63]
  v_mfma_f32_16x16x16_bf16 v[60:63], v[204:205], v[44:45], v[60:63]
  v_mfma_f32_16x16x16_bf16 v[60:63], v[204:205], v[48:49], v[60:63]
  v_mfma_f32_16x16x16_bf16 v[60:63], v[204:205], v[52:53], v[60:63]
  v_mfma_f32_16x16x16_bf16 v[60:63], v[204:205], v[56:57], v[60:63]
  v_add_f32 v64, v30, v34
  v_add_f32 v65, v38, v42
  v_add_f32 v66, v46, v50
  v_add_f32 v67, v54, v58
  v_add_f32 v64, v64, v65
  v_add_f32 v66, v66, v67
  v_add_f32 v64, v64, v66
  v_mov_b32 v65, v64
  s_lshr_b32 s40, s6, 5
  s_nop 0
  v_permlane32_swap_b32 v64, v65
  v_add_f32 v64, v64, v65
  v_mov_b32 v65, v64
  s_add_u32 s40, s40, 0
  s_nop 0
  v_permlane16_swap_b32 v64, v65
  v_add_f32 v64, v64, v65
  v_mov_b32_e64 v31, v245
  v_cvt_pk_bf16_f32 v28, v60, v61
  v_mov_b32_dpp v65, v64 quad_perm:[0,2,0,2] row_mask:0xf bank_mask:0xf
  v_mov_b32_dpp v66, v64 quad_perm:[1,3,1,3] row_mask:0xf bank_mask:0xf
  v_cvt_pk_bf16_f32 v29, v62, v63
  v_cvt_pk_bf16_f32 v30, v65, v66
  s_mov_b64 exec, 0xffff
  buffer_store_dwordx4 v[28:31], v246, s[28:31], s40 offen sc1
  s_mov_b64 exec, -1
  s_branch L_own_back_22
L_st_slow_25:
  buffer_store_dwordx2 v[34:35], v246, s[28:31], s65 offen sc1
  buffer_store_dwordx2 v[38:39], v246, s[28:31], s66 offen sc1
  buffer_store_dwordx2 v[42:43], v246, s[28:31], s67 offen sc1
  buffer_store_dwordx2 v[46:47], v246, s[28:31], s72 offen sc1
  s_branch L_st_done_26
L_left_27:
  s_branch L_left_back_28
L_fl_slow_30:
  buffer_store_dword v245, v244, s[28:31], s36 offen offset:8 sc1
  s_branch L_fl_skip_29
L_fl_slow_34:
  buffer_store_dword v245, v244, s[28:31], s36 offen offset:12 sc1
  s_branch L_fl_skip_33
L_fl_slow_38:
  buffer_store_dword v245, v244, s[28:31], s36 offen offset:16 sc1
  s_branch L_fl_skip_37
L_fl_slow_42:
  buffer_store_dword v245, v244, s[28:31], s36 offen offset:20 sc1
  s_branch L_fl_skip_41
L_pb_43:
  s_mov_b32 s57, 0
L_pb_loop_45:
  buffer_load_dword v3, v244, s[28:31], s90 offen offset:20 sc1
  s_waitcnt vmcnt(0)
  v_cmp_ne_u32_e64 vcc, s7, v3
  s_cbranch_vccz L_pb_back_44
  s_add_u32 s57, s57, 1
  s_cmp_le_u32 s57, 262144
  s_cbranch_scc1 L_pb_loop_45
  s_branch L_pb_back_44
L_last:
.section .rodata,"a"
.p2align 6
.amdhsa_kernel sequential_preLN__linear_kernel_hedgehog__dense_activation_gelu__prompt_kernel
  .amdhsa_next_free_vgpr 512
  .amdhsa_next_free_sgpr 102
  .amdhsa_accum_offset 256
  .amdhsa_group_segment_fixed_size 0
  .amdhsa_kernarg_size 96
  .amdhsa_user_sgpr_count 2
  .amdhsa_user_sgpr_kernarg_segment_ptr 1
  .amdhsa_system_sgpr_workgroup_id_x 1
.end_amdhsa_kernel
```
